```python
import torch

def _softmax(x, axis=-1):
    return torch.softmax(x, dim=axis)

def _gelu(x):
    return torch.nn.functional.gelu(x, approximate='tanh')

def _silu(x):
    return torch.nn.functional.silu(x)

def _sigmoid(x):
    return torch.sigmoid(x)

def _layernorm(x, axis=-1, eps=1e-05):
    m = x.mean(dim=axis, keepdim=True)
    v = x.var(dim=axis, keepdim=True, unbiased=False)
    return (x - m) / torch.sqrt(v + eps)

def _scatter_add(tgt, idx, src, axis=0):
    return tgt.clone().index_add_(axis, idx, src)

def _segment_sum(src, seg, n):
    out = torch.zeros((n,) + src.shape[1:], dtype=src.dtype)
    return out.index_add_(0, seg, src)

def _pad(x, pw):
    flat = tuple((v for pair in reversed(pw) for v in pair))
    return torch.nn.functional.pad(x, flat)
kernel_name = 'adaLN_cond__sliding_block_cached__swiglu_ffn__decode'

def setup_inputs():

    _w = lambda a: (lambda t: t.to(torch.bfloat16) if t.is_floating_point() else t)(torch.as_tensor(a))

    def _A_setup():
        B, Sq, D = (1, 1, 512)
        Hq, Hkv, Sk, Dh = (32, 8, 65536, 128)
        assert Hq % Hkv == 0, (Hq, Hkv)
        return {'x': _w((lambda *s: torch.randn(*s, dtype=torch.bfloat16) * 0.05)(B, Sq, D)), 'k_cache': _w((lambda *s: torch.randn(*s, dtype=torch.bfloat16) * 3.2)(B, Hkv, Sk, Dh)), 'v_cache': _w((lambda *s: torch.randn(*s, dtype=torch.bfloat16) * 0.4)(B, Hkv, Sk, Dh)), 'wq': _w((lambda *s: torch.randn(*s, dtype=torch.bfloat16) * 3.2)(D, Hq * Dh) * D ** (-0.5)), 'wo': _w((lambda *s: torch.randn(*s, dtype=torch.bfloat16) * 0.4)(Hq * Dh, D) * (Hq * Dh) ** (-0.5))}
    _A_in = _A_setup()

    def _B_setup():
        B, S, D, F = (1, 1, 512, 1792)
        return {'x': _w((lambda *s: torch.randn(*s, dtype=torch.bfloat16) * 0.05)(B, S, D)), 'w_gate': _w((lambda *s: torch.randn(*s, dtype=torch.bfloat16) * 0.05)(D, F)), 'w_up': _w((lambda *s: torch.randn(*s, dtype=torch.bfloat16) * 0.05)(D, F)), 'w_down': _w((lambda *s: torch.randn(*s, dtype=torch.bfloat16) * 0.05)(F, D))}
    _B_in = _B_setup()
    return {'A_x': _A_in['x'], 'A_k_cache': _A_in['k_cache'], 'A_v_cache': _A_in['v_cache'], 'A_wq': _A_in['wq'], 'A_wo': _A_in['wo'], 'B_x': _B_in['x'], 'B_w_gate': _B_in['w_gate'], 'B_w_up': _B_in['w_up'], 'B_w_down': _B_in['w_down'], 'c': _w((lambda *s: torch.randn(*s, dtype=torch.bfloat16) * 0.1)(1, 512) * 8.0), 'w_mod': _w((lambda *s: torch.randn(*s, dtype=torch.bfloat16) * 0.1)(512, 6 * 512) * 512 ** (-0.5) * 8.0)}

def reference(A_x, A_k_cache, A_v_cache, A_wq, A_wo, B_x, B_w_gate, B_w_up, B_w_down, c, w_mod):

    def _A_ref(x, k_cache, v_cache, wq, wo):
        B, Sq, D = x.shape
        Hq, Dh = (32, 128)
        Hkv, Sk = (k_cache.shape[1], k_cache.shape[2])
        W = min(4096, max(256, Sk // 4))
        rep = Hq // Hkv
        q = (lambda x, *d: x.permute(*d))((x @ wq).reshape(B, Sq, Hq, Dh), 0, 2, 1, 3)
        k = (lambda x, n, axis: torch.repeat_interleave(x, n, dim=axis))(k_cache[:, :, Sk - W:, :], rep, axis=1)
        v = (lambda x, n, axis: torch.repeat_interleave(x, n, dim=axis))(v_cache[:, :, Sk - W:, :], rep, axis=1)
        scores = torch.einsum('bhqd,bhkd->bhqk', q, k) * Dh ** (-0.5)
        p = _softmax(scores, axis=-1)
        o = torch.einsum('bhqk,bhkd->bhqd', p, v)
        return (lambda x, *d: x.permute(*d))(o, 0, 2, 1, 3).reshape(B, Sq, Hq * Dh) @ wo

    def _B_ref(x, w_gate, w_up, w_down):
        g = _silu(x @ w_gate)
        u = x @ w_up
        return g * u @ w_down
    x = A_x
    mod = (_silu(c) @ w_mod).reshape(c.shape[0], 6, 1, -1)
    sa, ca, ga, sb, cb, gb = (mod[:, 0].clone(), mod[:, 1].clone(), mod[:, 2].clone(), mod[:, 3].clone(), mod[:, 4].clone(), mod[:, 5].clone())
    h = _layernorm(x, axis=-1) * (1 + ca) + sa
    x = x + ga * _A_ref(h, A_k_cache, A_v_cache, A_wq, A_wo)
    h = _layernorm(x, axis=-1) * (1 + cb) + sb
    x = x + gb * _B_ref(h, B_w_gate, B_w_up, B_w_down)
    return x
```

```asm
; @launch grid=(256,1,1) block=(256,1,1) lds=139264
.amdgcn_target "amdgcn-amd-amdhsa--gfx950"
.text
.globl adaLN_cond__sliding_block_cached__swiglu_ffn__decode_kernel
.p2align 8
.type adaLN_cond__sliding_block_cached__swiglu_ffn__decode_kernel,@function
adaLN_cond__sliding_block_cached__swiglu_ffn__decode_kernel:
    s_cmp_ge_u32 s2, 256
    s_cbranch_scc1 L_end
    s_load_dwordx2 s[20:21], s[0:1], 24
    s_cmp_ge_u32 s2, 128
    s_cselect_b32 s8, 80, 8
    s_cselect_b32 s9, 72, 16
    s_load_dwordx2 s[24:25], s[0:1], s8
    s_load_dwordx2 s[28:29], s[0:1], s9
    s_load_dwordx2 s[16:17], s[0:1], 104
    s_getpc_b64 s[14:15]
L_pc:
    s_lshr_b32 s5, s2, 3
    s_lshl_b32 s8, s5, 9
    v_and_b32 v4, 0xc0, v0
    v_lshl_add_u32 v4, v4, 1, s8
    v_min_u32 v4, L_codeend-L_pc-1028, v4
    global_load_dword v4, v4, s[14:15] offset:1024
    v_lshrrev_b32 v6, 6, v0
    v_and_b32 v1, 63, v0
    v_readfirstlane_b32 s3, v6
    s_and_b32 s4, s2, 7
    v_bfe_u32 v2, v0, 4, 2
    v_and_b32 v3, 15, v0
    s_mov_b32 s27, 0x20000
    s_mov_b32 s31, 0x20000
    s_mov_b32 s22, 4194304
    s_mov_b32 s23, 0x20000
    s_cmp_ge_u32 s2, 128
    s_cbranch_scc1 L_W
    s_mov_b32 s26, 134217728
    v_xor_b32 v6, v3, v2
    v_lshlrev_b32 v6, 4, v6
    v_lshl_or_b32 v18, v2, 8, v6
    v_xor_b32 v19, 0x40, v18
    v_xor_b32 v20, 0x80, v18
    v_xor_b32 v21, 0xc0, v18
    s_lshl_b32 s43, s4, 24
    s_lshl_b32 s8, s5, 12
    s_or_b32 s43, s43, s8
    s_lshl_b32 s8, s3, 16
    s_or_b32 s43, s43, s8
    s_or_b32 s43, s43, 0xf00000
    s_lshl_b32 s41, s3, 14
    v_lshrrev_b32 v6, 3, v1
    v_and_b32 v7, 7, v1
    v_lshlrev_b32 v7, 7, v7
    v_lshl_or_b32 v24, v6, 13, v7
    s_lshl_b32 s44, s5, 2
    s_add_u32 s44, s44, s3
    s_lshl_b32 s45, s44, 16
    s_lshl_b32 s8, s4, 10
    s_add_u32 s45, s45, s8
    s_xor_b32 s37, s43, 0x0
    s_xor_b32 s38, s43, 0x42000
    s_waitcnt lgkmcnt(0)
    s_load_dword s6, s[16:17], 0x0
    s_xor_b32 s39, s43, 0x82000
    s_xor_b32 s40, s43, 0xc0000
    s_mov_b32 s30, 134217728
    s_lshl_b32 s42, s3, 12
    s_add_u32 s42, s42, 65536
    v_lshlrev_b32 v6, 1, v2
    v_xor_b32 v7, v3, v6
    v_lshlrev_b32 v7, 4, v7
    v_lshl_or_b32 v22, v2, 8, v7
    v_xor_b32 v23, 0x80, v22
    v_xor_b32 v6, v3, v2
    v_lshlrev_b32 v6, 4, v6
    v_lshl_or_b32 v6, v3, 8, v6
    v_add_u32 v30, s41, v6
    v_xor_b32 v31, 0x40, v30
    v_xor_b32 v32, 0x80, v30
    v_xor_b32 v33, 0xc0, v30
    v_lshlrev_b32 v28, 4, v1
    buffer_load_dword v24, v24, s[20:23], s45 offen
    s_branch L_A
L_W:
    s_load_dwordx2 s[32:33], s[0:1], 0
    s_mov_b32 s26, 3145728
    s_mov_b32 s30, 1024
    s_sub_u32 s36, s5, 16
    s_lshr_b32 s37, s4, 1
    s_lshr_b32 s39, s36, 3
    s_and_b32 s38, s4, 1
    s_lshl_b32 s38, s38, 4
    s_add_u32 s38, s38, s36
    v_and_b32 v6, 1, v2
    v_lshlrev_b32 v6, 1, v6
    v_and_b32 v7, 3, v1
    v_xor_b32 v6, v6, v7
    v_lshrrev_b32 v7, 2, v1
    v_mul_u32_u24 v7, 6144, v7
    v_lshl_add_u32 v19, v6, 4, v7
    s_mul_i32 s46, s37, 786432
    s_lshl_b32 s8, s38, 6
    s_add_u32 s8, s8, s46
    s_add_u32 s9, s8, 393216
    s_bitcmp1_b32 s2, 3
    s_cselect_b32 s11, s8, s9
    s_cselect_b32 s8, s9, s8
    v_lshlrev_b32 v27, 2, v1
    v_lshlrev_b32 v26, 4, v1
    s_lshr_b32 s10, s4, 2
    s_lshl_b32 s10, s10, 9
    s_mov_b32 m0, 0
    s_mov_b32 s34, 1024
    s_mov_b32 s35, 0x20000
    s_lshl_b32 s12, s39, 1
    s_add_u32 s12, s12, s3
    s_sub_u32 s12, s12, 2
    s_lshl_b32 s13, s12, 8
    s_mov_b32 s18, 1015808
    s_mov_b32 s19, 0x20000
    s_cmp_lg_u32 s3, 0
    s_waitcnt lgkmcnt(0)
    s_load_dword s6, s[16:17], 0x0
    s_cbranch_scc1 L_w0skip
    buffer_load_dword v28, v27, s[28:31], s10 offen
    buffer_load_dword v29, v27, s[28:31], s10 offen offset:256
    buffer_load_dwordx4 v19, s[24:27], s8 offen offset:0  lds
    s_add_u32 s8, s8, 97280
    buffer_load_dwordx4 v19, s[24:27], s8 offen offset:1024  lds
    s_add_u32 s8, s8, 97280
    buffer_load_dwordx4 v19, s[24:27], s8 offen offset:2048  lds
    s_add_u32 s8, s8, 97280
    buffer_load_dwordx4 v19, s[24:27], s8 offen offset:3072  lds
    s_mov_b32 m0, 4096
    s_nop 0
    buffer_load_dwordx4 v19, s[24:27], s11 offen offset:0  lds
    s_add_u32 s11, s11, 97280
    buffer_load_dwordx4 v19, s[24:27], s11 offen offset:1024  lds
    s_add_u32 s11, s11, 97280
    buffer_load_dwordx4 v19, s[24:27], s11 offen offset:2048  lds
    s_add_u32 s11, s11, 97280
    buffer_load_dwordx4 v19, s[24:27], s11 offen offset:3072  lds
    s_branch L_xskip
L_w0skip:
    s_cmp_ge_u32 s3, 2
    s_cbranch_scc1 L_xload
    s_and_b32 s48, s4, 4
    s_add_u32 s48, s48, s4
    s_lshl_b32 s48, s48, 4
    s_add_u32 s48, s48, s36
    s_lshl_b32 s48, s48, 7
    s_add_u32 s48, s48, 491520
    v_and_b32 v10, 127, v27
    v_lshrrev_b32 v7, 5, v1
    v_lshl_or_b32 v6, v7, 13, v10
    v_mov_b32 v22, -1
    buffer_store_dword v22, v6, s[16:19], s48 offen sc1
    s_branch L_xskip
L_xload:
    buffer_load_dwordx4 v[30:33], v26, s[32:35], 0 offen
    buffer_load_dword v28, v27, s[32:35], s13 offen
L_xskip:
    v_lshlrev_b32 v6, 1, v2
    v_and_b32 v7, 7, v1
    v_xor_b32 v6, v6, v7
    v_lshlrev_b32 v17, 4, v6
    v_lshrrev_b32 v18, 3, v1
    v_lshl_or_b32 v20, v18, 13, v17
    s_and_b32 s49, s36, 7
    s_lshl_b32 s40, s4, 3
    s_add_u32 s40, s40, s49
    s_lshl_b32 s9, s12, 20
    s_lshl_b32 s10, s40, 7
    s_add_u32 s44, s9, s10
    s_lshl_b32 s45, s3, 14
    s_sub_u32 s45, s45, 24576
    v_lshlrev_b32 v7, 1, v1
    v_and_b32 v34, 0xffffffe3, v7
    v_bfe_u32 v6, v7, 2, 2
    v_lshl_or_b32 v34, v6, 3, v34
    v_bfe_u32 v6, v7, 4, 1
    v_lshl_or_b32 v34, v6, 2, v34
    v_lshlrev_b32 v34, 1, v34
    v_and_b32 v7, 3, v1
    v_lshrrev_b32 v8, 2, v1
    v_bfe_u32 v6, v1, 3, 2
    v_xor_b32 v6, s3, v6
    v_lshlrev_b32 v6, 5, v6
    v_lshl_or_b32 v6, v7, 3, v6
    v_lshl_or_b32 v35, v8, 7, v6
    v_lshlrev_b32 v36, 4, v2
    s_lshl_b32 s10, s3, 7
    v_and_b32 v6, 1, v1
    v_lshlrev_b32 v6, 4, v6
    v_lshl_add_u32 v6, v2, 5, v6
    v_add_u32 v37, s10, v6
    v_mul_u32_u24 v42, 6144, v18
    v_add_u32 v42, v42, v17
    s_and_b32 s8, s4, 4
    s_add_u32 s8, s8, s3
    s_mul_i32 s46, s8, 393216
    s_and_b32 s50, s40, 31
    s_xor_b32 s50, s50, 0
    s_lshl_b32 s8, s50, 7
    s_add_u32 s46, s46, s8
    s_add_u32 s46, s46, 2048
    s_lshl_b32 s47, s4, 4
    s_add_u32 s47, s47, s36
    s_lshl_b32 s47, s47, 9
    s_add_u32 s47, s47, 278528
    s_mov_b32 s42, 0xaaaaaaaa
    s_mov_b32 s43, 0xaaaaaaaa
    s_cmp_ge_u32 s3, 2
    s_cbranch_scc1 L_w23
    s_cmp_eq_u32 s3, 1
    s_cbranch_scc1 L_w1
    v_and_b32 v6, 1, v2
    v_lshlrev_b32 v6, 5, v6
    v_lshl_or_b32 v6, v7, 3, v6
    v_lshl_or_b32 v116, v8, 6, v6
    v_xor_b32 v11, 32, v116
    v_bfe_u32 v6, v1, 1, 2
    v_lshl_add_u32 v117, v6, 16, v37
    v_bfe_u32 v6, v1, 3, 1
    v_lshl_add_u32 v117, v6, 13, v117
    s_lshl_b32 s13, s37, 14
    s_lshl_b32 s8, s38, 8
    s_add_u32 s13, s13, s8
    s_add_u32 s13, s13, 16384
    s_lshl_b32 s8, s36, 7
    s_and_b32 s8, s8, 128
    s_and_b32 s9, s37, 1
    s_lshl_b32 s9, s9, 8
    s_add_u32 s8, s8, s9
    v_add_u32 v12, s8, v36
    v_xor_b32 v13, 128, v12
    s_waitcnt lgkmcnt(0)
    s_mul_i32 s6, s6, 0x41c64e61
    s_add_u32 s6, s6, 0x3c6ef357
    s_bitset0_b32 s6, 31
    v_mov_b32 v39, s6
    v_mov_b32 v41, s6
    v_mov_b32 v149, s6
    v_mov_b32 v151, s6
    s_waitcnt vmcnt(8)
    v_lshlrev_b32 v76, 16, v28
    v_and_b32 v77, 0xffff0000, v28
    v_lshlrev_b32 v78, 16, v29
    v_and_b32 v79, 0xffff0000, v29
    v_mul_f32 v80, 0xbfb8aa3b, v76
    v_mul_f32 v81, 0xbfb8aa3b, v77
    v_mul_f32 v82, 0xbfb8aa3b, v78
    v_mul_f32 v83, 0xbfb8aa3b, v79
    v_exp_f32 v80, v80
    v_exp_f32 v81, v81
    v_exp_f32 v82, v82
    v_exp_f32 v83, v83
    v_add_f32 v80, 1.0, v80
    v_add_f32 v81, 1.0, v81
    v_add_f32 v82, 1.0, v82
    v_add_f32 v83, 1.0, v83
    v_rcp_f32 v80, v80
    v_rcp_f32 v81, v81
    v_rcp_f32 v82, v82
    v_rcp_f32 v83, v83
    v_pk_mul_f32 v[76:77], v[76:77], v[80:81]
    v_cvt_pk_bf16_f32 v6, v76, v77
    ds_write_b32 v34, v6 offset:56832
    v_pk_mul_f32 v[78:79], v[78:79], v[82:83]
    v_cvt_pk_bf16_f32 v7, v78, v79
    ds_write_b32 v34, v7 offset:57088
    ds_read_b128 v[76:79], v12 offset:56832
    ds_read_b128 v[80:83], v12 offset:56896
    ds_read_b128 v[84:87], v13 offset:56832
    ds_read_b128 v[88:91], v13 offset:56896
    s_waitcnt vmcnt(4)
    ds_read_b64_tr_b16 v[44:45], v116 offset:0
    ds_read_b64_tr_b16 v[46:47], v116 offset:1024
    ds_read_b64_tr_b16 v[60:61], v11 offset:0
    ds_read_b64_tr_b16 v[62:63], v11 offset:1024
    ds_read_b64_tr_b16 v[48:49], v116 offset:2048
    ds_read_b64_tr_b16 v[50:51], v116 offset:3072
    ds_read_b64_tr_b16 v[64:65], v11 offset:2048
    ds_read_b64_tr_b16 v[66:67], v11 offset:3072
    s_waitcnt lgkmcnt(6)
    v_mfma_f32_16x16x32_bf16 v[108:111], v[44:47], v[76:79], 0
    s_waitcnt lgkmcnt(4)
    v_mfma_f32_16x16x32_bf16 v[112:115], v[60:63], v[76:79], 0
    s_waitcnt lgkmcnt(2)
    v_mfma_f32_16x16x32_bf16 v[108:111], v[48:51], v[80:83], v[108:111]
    s_waitcnt lgkmcnt(0)
    v_mfma_f32_16x16x32_bf16 v[112:115], v[64:67], v[80:83], v[112:115]
    s_waitcnt vmcnt(0)
    ds_read_b64_tr_b16 v[52:53], v116 offset:4096
    ds_read_b64_tr_b16 v[54:55], v116 offset:5120
    ds_read_b64_tr_b16 v[68:69], v11 offset:4096
    ds_read_b64_tr_b16 v[70:71], v11 offset:5120
    ds_read_b64_tr_b16 v[56:57], v116 offset:6144
    ds_read_b64_tr_b16 v[58:59], v116 offset:7168
    ds_read_b64_tr_b16 v[72:73], v11 offset:6144
    ds_read_b64_tr_b16 v[74:75], v11 offset:7168
    s_waitcnt lgkmcnt(6)
    v_mfma_f32_16x16x32_bf16 v[108:111], v[52:55], v[84:87], v[108:111]
    s_waitcnt lgkmcnt(4)
    v_mfma_f32_16x16x32_bf16 v[112:115], v[68:71], v[84:87], v[112:115]
    s_waitcnt lgkmcnt(2)
    v_mfma_f32_16x16x32_bf16 v[108:111], v[56:59], v[88:91], v[108:111]
    s_waitcnt lgkmcnt(0)
    v_mfma_f32_16x16x32_bf16 v[112:115], v[72:75], v[88:91], v[112:115]
    s_mov_b32 exec_lo, 0x33333333
    s_mov_b32 exec_hi, 0x33333333
    s_nop 3
    v_cndmask_b32 v38, v108, v110, s[42:43]
    v_cndmask_b32 v40, v109, v111, s[42:43]
    buffer_store_dwordx4 v[38:41], v117, s[16:19], s13 offen offset:0 sc1
    v_cndmask_b32 v148, v112, v114, s[42:43]
    v_cndmask_b32 v150, v113, v115, s[42:43]
    buffer_store_dwordx4 v[148:151], v117, s[16:19], s13 offen offset:128 sc1
    s_mov_b64 exec, -1
    s_barrier
    s_branch L_w01
L_w1:
    v_mov_b32 v22, -1
    v_mov_b32 v23, -1
    v_mov_b32 v24, -1
    v_mov_b32 v25, -1
    s_mov_b32 exec_lo, 0xffffffff
    s_mov_b32 exec_hi, 0x0
    buffer_store_dwordx4 v[22:25], v26, s[16:19], s47 offen
    s_mov_b64 exec, -1
    s_cmp_eq_u32 s39, 1
    s_cbranch_scc1 L_w1b
    s_lshl_b32 s8, s40, 12
    s_add_u32 s8, s8, 540672
    buffer_store_dwordx4 v[22:25], v26, s[16:19], s8 offen offset:0 sc1
    buffer_store_dwordx4 v[22:25], v26, s[16:19], s8 offen offset:1024 sc1
    buffer_store_dwordx4 v[22:25], v26, s[16:19], s8 offen offset:2048 sc1
    buffer_store_dwordx4 v[22:25], v26, s[16:19], s8 offen offset:3072 sc1
    s_branch L_w1done
L_w1b:
    s_lshl_b32 s8, s40, 11
    s_add_u32 s8, s8, 802816
    buffer_store_dwordx4 v[22:25], v26, s[16:19], s8 offen sc1
    buffer_store_dwordx4 v[22:25], v26, s[16:19], s8 offen offset:1024 sc1
    s_lshl_b32 s8, s49, 3
    s_add_u32 s8, s8, s4
    s_lshl_b32 s8, s8, 10
    s_add_u32 s8, s8, 933888
    buffer_store_dwordx4 v[22:25], v26, s[16:19], s8 offen sc1
    s_add_u32 s8, s8, 0x10000
    buffer_store_dwordx4 v[22:25], v26, s[16:19], s8 offen sc1
L_w1done:
    s_barrier
    s_waitcnt lgkmcnt(0)
    s_mul_i32 s6, s6, 0x41c64e61
    s_add_u32 s6, s6, 0x3c6ef357
    s_bitset0_b32 s6, 31
    v_mov_b32 v39, s6
    v_mov_b32 v41, s6
    s_and_b32 s10, s36, 1
    s_lshl_b32 s11, s10, 13
    s_add_u32 s12, s48, 8192
    s_sub_u32 s12, s12, s11
    s_add_u32 s11, s48, s11
    s_mov_b32 s9, 0
    s_waitcnt vmcnt(5)
    s_load_dword s8, s[16:17], s12
    s_load_dword s9, s[16:17], s11
    s_getreg_b32 s11, hwreg(HW_REG_XCC_ID, 2, 1)
    s_xor_b32 s10, s10, s11
    s_add_u32 s10, s10, 1
    s_lshl_b32 s11, s4, 4
    s_add_u32 s11, s11, s36
    s_lshl_b32 s11, s11, 7
    s_add_u32 s11, s11, 524288
    s_waitcnt lgkmcnt(1)
    s_and_b32 s10, s10, s9
    s_xor_b32 s10, s10, s6
    v_mov_b32 v6, s10
    s_mov_b32 exec_lo, 0xffffffff
    s_mov_b32 exec_hi, 0x0
    buffer_store_dword v6, v27, s[16:19], s11 offen sc1
    s_mov_b64 exec, -1
    s_waitcnt lgkmcnt(0)
L_w01:
    s_barrier
    ds_read_b64_tr_b16 v[44:45], v35 offset:8192
    ds_read_b64_tr_b16 v[46:47], v35 offset:10240
    ds_read_b64_tr_b16 v[48:49], v35 offset:12288
    ds_read_b64_tr_b16 v[50:51], v35 offset:14336
    ds_read_b64_tr_b16 v[52:53], v35 offset:16384
    ds_read_b64_tr_b16 v[54:55], v35 offset:18432
    ds_read_b64_tr_b16 v[56:57], v35 offset:20480
    ds_read_b64_tr_b16 v[58:59], v35 offset:22528
    ds_read_b64_tr_b16 v[60:61], v35 offset:24576
    ds_read_b64_tr_b16 v[62:63], v35 offset:26624
    ds_read_b64_tr_b16 v[64:65], v35 offset:28672
    ds_read_b64_tr_b16 v[66:67], v35 offset:30720
    ds_read_b64_tr_b16 v[68:69], v35 offset:32768
    ds_read_b64_tr_b16 v[70:71], v35 offset:34816
    ds_read_b64_tr_b16 v[72:73], v35 offset:36864
    ds_read_b64_tr_b16 v[74:75], v35 offset:38912
    s_cmp_eq_u32 s3, 0
    s_cbranch_scc1 L_hjoin
    s_waitcnt vmcnt(1)
    s_branch L_hjoin
L_w23:
    s_and_b32 s9, s4, 6
    s_and_b32 s51, s9, 3
    s_lshl_b32 s51, s51, 16
    s_lshr_b32 s8, s9, 2
    s_lshl_b32 s8, s8, 13
    s_or_b32 s51, s51, s8
    s_lshl_b32 s9, s12, 10
    s_add_u32 s51, s51, s9
    s_add_u32 s51, s51, 16384
    s_add_u32 s52, s51, 16384
    s_add_u32 s53, s51, 32768
    s_add_u32 s54, s51, 49152
    v_add_u32 v152, 4096, v26
    s_lshl_b32 s9, s3, 8
    v_add_u32 v34, s9, v34
    s_waitcnt lgkmcnt(0)
    s_mul_i32 s6, s6, 0x41c64e61
    s_add_u32 s6, s6, 0x3c6ef357
    s_bitset0_b32 s6, 31
    v_mov_b32 v39, s6
    v_mov_b32 v41, s6
    s_waitcnt vmcnt(0)
    v_lshlrev_b32 v76, 16, v30
    v_and_b32 v77, 0xffff0000, v30
    v_lshlrev_b32 v78, 16, v31
    v_and_b32 v79, 0xffff0000, v31
    v_lshlrev_b32 v80, 16, v32
    v_and_b32 v81, 0xffff0000, v32
    v_lshlrev_b32 v82, 16, v33
    v_and_b32 v83, 0xffff0000, v33
    v_pk_add_f32 v[6:7], v[76:77], v[78:79]
    v_pk_add_f32 v[8:9], v[80:81], v[82:83]
    v_pk_add_f32 v[6:7], v[6:7], v[8:9]
    v_add_f32 v153, v6, v7
    s_nop 1
    v_add_f32_dpp v153, v153, v153 row_ror:8 row_mask:0xf bank_mask:0xf
    s_nop 1
    v_add_f32_dpp v153, v153, v153 row_ror:4 row_mask:0xf bank_mask:0xf
    s_nop 1
    v_add_f32_dpp v153, v153, v153 row_ror:2 row_mask:0xf bank_mask:0xf
    s_nop 1
    v_add_f32_dpp v153, v153, v153 row_ror:1 row_mask:0xf bank_mask:0xf
    v_mov_b32 v6, v153
    s_nop 1
    v_permlane16_swap_b32 v153, v6
    v_add_f32 v153, v153, v6
    v_mov_b32 v6, v153
    s_nop 1
    v_permlane32_swap_b32 v153, v6
    v_add_f32 v153, v153, v6
    v_mul_f32 v153, 0x3b000000, v153
    v_sub_f32 v76, v76, v153
    v_sub_f32 v77, v77, v153
    v_sub_f32 v78, v78, v153
    v_sub_f32 v79, v79, v153
    v_sub_f32 v80, v80, v153
    v_sub_f32 v81, v81, v153
    v_sub_f32 v82, v82, v153
    v_sub_f32 v83, v83, v153
    v_pk_mul_f32 v[76:77], v[76:77], v[76:77]
    v_pk_mul_f32 v[78:79], v[78:79], v[78:79]
    v_pk_mul_f32 v[80:81], v[80:81], v[80:81]
    v_pk_mul_f32 v[82:83], v[82:83], v[82:83]
    v_pk_add_f32 v[6:7], v[76:77], v[78:79]
    v_pk_add_f32 v[8:9], v[80:81], v[82:83]
    v_pk_add_f32 v[6:7], v[6:7], v[8:9]
    v_add_f32 v154, v6, v7
    s_nop 1
    v_add_f32_dpp v154, v154, v154 row_ror:8 row_mask:0xf bank_mask:0xf
    s_nop 1
    v_add_f32_dpp v154, v154, v154 row_ror:4 row_mask:0xf bank_mask:0xf
    s_nop 1
    v_add_f32_dpp v154, v154, v154 row_ror:2 row_mask:0xf bank_mask:0xf
    s_nop 1
    v_add_f32_dpp v154, v154, v154 row_ror:1 row_mask:0xf bank_mask:0xf
    v_mov_b32 v6, v154
    s_nop 1
    v_permlane16_swap_b32 v154, v6
    v_add_f32 v154, v154, v6
    v_mov_b32 v6, v154
    s_nop 1
    v_permlane32_swap_b32 v154, v6
    v_add_f32 v154, v154, v6
    v_mul_f32 v154, 0x3b000000, v154
    v_cvt_pk_bf16_f32 v153, 0, v153
    v_cvt_pk_bf16_f32 v154, 0, v154
    v_add_f32 v154, 0x3727c5ac, v154
    v_cvt_pk_bf16_f32 v154, 0, v154
    v_sqrt_f32 v154, v154
    v_lshlrev_b32 v156, 16, v28
    v_and_b32 v157, 0xffff0000, v28
    v_cvt_pk_bf16_f32 v154, 0, v154
    v_rcp_f32 v154, v154
    v_sub_f32 v156, v156, v153
    v_cvt_pk_bf16_f32 v156, 0, v156
    v_sub_f32 v157, v157, v153
    v_cvt_pk_bf16_f32 v157, 0, v157
    v_mul_f32 v156, v156, v154
    v_cvt_pk_bf16_f32 v156, 0, v156
    v_mul_f32 v157, v157, v154
    v_cvt_pk_bf16_f32 v157, 0, v157
    s_barrier
    s_add_u32 m0, s45, 0
    s_add_u32 s8, s44, 0
    buffer_load_dwordx4 v20, s[20:23], s8 offen offset:0 nt lds
    s_add_u32 s8, s44, 64512
    buffer_load_dwordx4 v20, s[20:23], s8 offen offset:1024 nt lds
    s_add_u32 s8, s44, 129024
    buffer_load_dwordx4 v20, s[20:23], s8 offen offset:2048 nt lds
    s_add_u32 s8, s44, 193536
    buffer_load_dwordx4 v20, s[20:23], s8 offen offset:3072 nt lds
    s_add_u32 m0, s45, 4096
    s_add_u32 s8, s44, 262144
    buffer_load_dwordx4 v20, s[20:23], s8 offen offset:0 nt lds
    s_add_u32 s8, s44, 326656
    buffer_load_dwordx4 v20, s[20:23], s8 offen offset:1024 nt lds
    s_add_u32 s8, s44, 391168
    buffer_load_dwordx4 v20, s[20:23], s8 offen offset:2048 nt lds
    s_add_u32 s8, s44, 455680
    buffer_load_dwordx4 v20, s[20:23], s8 offen offset:3072 nt lds
    s_add_u32 m0, s45, 8192
    s_add_u32 s8, s44, 524288
    buffer_load_dwordx4 v20, s[20:23], s8 offen offset:0 nt lds
    s_add_u32 s8, s44, 588800
    buffer_load_dwordx4 v20, s[20:23], s8 offen offset:1024 nt lds
    s_add_u32 s8, s44, 653312
    buffer_load_dwordx4 v20, s[20:23], s8 offen offset:2048 nt lds
    s_add_u32 s8, s44, 717824
    buffer_load_dwordx4 v20, s[20:23], s8 offen offset:3072 nt lds
    s_add_u32 m0, s45, 12288
    s_add_u32 s8, s44, 786432
    buffer_load_dwordx4 v20, s[20:23], s8 offen offset:0 nt lds
    s_add_u32 s8, s44, 850944
    buffer_load_dwordx4 v20, s[20:23], s8 offen offset:1024 nt lds
    s_add_u32 s8, s44, 915456
    buffer_load_dwordx4 v20, s[20:23], s8 offen offset:2048 nt lds
    s_add_u32 s8, s44, 979968
    buffer_load_dwordx4 v20, s[20:23], s8 offen offset:3072 nt lds
    s_waitcnt vmcnt(0)
    buffer_load_dwordx4 v[116:119], v152, s[16:19], s51 offen sc1
    buffer_load_dwordx4 v[120:123], v152, s[16:19], s52 offen sc1
    buffer_load_dwordx4 v[124:127], v152, s[16:19], s53 offen sc1
    buffer_load_dwordx4 v[128:131], v152, s[16:19], s54 offen sc1
    buffer_load_dwordx4 v[132:135], v26, s[16:19], s51 offen sc1
    buffer_load_dwordx4 v[136:139], v26, s[16:19], s52 offen sc1
    buffer_load_dwordx4 v[140:143], v26, s[16:19], s53 offen sc1
    buffer_load_dwordx4 v[144:147], v26, s[16:19], s54 offen sc1
    s_barrier
    ds_read_b64_tr_b16 v[44:45], v35 offset:8192
    ds_read_b64_tr_b16 v[46:47], v35 offset:10240
    ds_read_b64_tr_b16 v[48:49], v35 offset:12288
    ds_read_b64_tr_b16 v[50:51], v35 offset:14336
    ds_read_b64_tr_b16 v[52:53], v35 offset:16384
    ds_read_b64_tr_b16 v[54:55], v35 offset:18432
    ds_read_b64_tr_b16 v[56:57], v35 offset:20480
    ds_read_b64_tr_b16 v[58:59], v35 offset:22528
    ds_read_b64_tr_b16 v[60:61], v35 offset:24576
    ds_read_b64_tr_b16 v[62:63], v35 offset:26624
    ds_read_b64_tr_b16 v[64:65], v35 offset:28672
    ds_read_b64_tr_b16 v[66:67], v35 offset:30720
    ds_read_b64_tr_b16 v[68:69], v35 offset:32768
    ds_read_b64_tr_b16 v[70:71], v35 offset:34816
    ds_read_b64_tr_b16 v[72:73], v35 offset:36864
    ds_read_b64_tr_b16 v[74:75], v35 offset:38912
    s_waitcnt vmcnt(0)
    s_mov_b32 s7, 0
    s_branch L_h_chk_7
L_h_retry_6:
    s_add_u32 s7, s7, 1
    s_cmp_gt_u32 s7, 1048576
    s_cbranch_scc1 L_h_done_8
    s_mov_b64 exec, vcc
    buffer_load_dwordx4 v[116:119], v152, s[16:19], s51 offen sc1
    buffer_load_dwordx4 v[120:123], v152, s[16:19], s52 offen sc1
    buffer_load_dwordx4 v[124:127], v152, s[16:19], s53 offen sc1
    buffer_load_dwordx4 v[128:131], v152, s[16:19], s54 offen sc1
    buffer_load_dwordx4 v[132:135], v26, s[16:19], s51 offen sc1
    buffer_load_dwordx4 v[136:139], v26, s[16:19], s52 offen sc1
    buffer_load_dwordx4 v[140:143], v26, s[16:19], s53 offen sc1
    buffer_load_dwordx4 v[144:147], v26, s[16:19], s54 offen sc1
    s_mov_b64 exec, -1
    s_waitcnt vmcnt(0)
L_h_chk_7:
    v_xor_b32 v6, s6, v117
    v_bitop3_b32 v6, v6, v119, s6 bitop3:0xf6
    v_bitop3_b32 v6, v6, v121, s6 bitop3:0xf6
    v_bitop3_b32 v6, v6, v123, s6 bitop3:0xf6
    v_bitop3_b32 v6, v6, v125, s6 bitop3:0xf6
    v_bitop3_b32 v6, v6, v127, s6 bitop3:0xf6
    v_bitop3_b32 v6, v6, v129, s6 bitop3:0xf6
    v_bitop3_b32 v6, v6, v131, s6 bitop3:0xf6
    v_bitop3_b32 v6, v6, v133, s6 bitop3:0xf6
    v_bitop3_b32 v6, v6, v135, s6 bitop3:0xf6
    v_bitop3_b32 v6, v6, v137, s6 bitop3:0xf6
    v_bitop3_b32 v6, v6, v139, s6 bitop3:0xf6
    v_bitop3_b32 v6, v6, v141, s6 bitop3:0xf6
    v_bitop3_b32 v6, v6, v143, s6 bitop3:0xf6
    v_bitop3_b32 v6, v6, v145, s6 bitop3:0xf6
    v_bitop3_b32 v6, v6, v147, s6 bitop3:0xf6
    v_cmp_ne_u32 vcc, 0, v6
    s_cbranch_vccnz L_h_retry_6
L_h_done_8:
    v_add_f32 v116, v116, v124
    v_add_f32 v120, v120, v128
    v_add_f32 v118, v118, v126
    v_add_f32 v122, v122, v130
    v_add_f32 v6, v116, v120
    v_add_f32 v7, v118, v122
    v_add_f32 v132, v132, v140
    v_add_f32 v136, v136, v144
    v_add_f32 v134, v134, v142
    v_add_f32 v138, v138, v146
    v_add_f32 v8, v132, v136
    v_add_f32 v9, v134, v138
    v_cvt_pk_bf16_f32 v6, 0, v6
    v_cvt_pk_bf16_f32 v7, 0, v7
    v_cvt_pk_bf16_f32 v8, 0, v8
    v_cvt_pk_bf16_f32 v9, 0, v9
    v_add_f32 v6, 1.0, v6
    v_add_f32 v7, 1.0, v7
    v_cvt_pk_bf16_f32 v6, 0, v6
    v_cvt_pk_bf16_f32 v7, 0, v7
    v_pk_mul_f32 v[6:7], v[6:7], v[156:157]
    v_cvt_pk_bf16_f32 v6, 0, v6
    v_cvt_pk_bf16_f32 v7, 0, v7
    v_pk_add_f32 v[6:7], v[6:7], v[8:9]
    v_cvt_pk_bf16_f32 v6, v6, v7
    ds_write_b32 v34, v6 offset:57088
    s_waitcnt vmcnt(0)
L_hjoin:
    s_waitcnt lgkmcnt(0)
    s_barrier
    ds_read_b128 v[76:79], v36 offset:57600
    ds_read_b128 v[80:83], v36 offset:57664
    ds_read_b128 v[84:87], v36 offset:57728
    ds_read_b128 v[88:91], v36 offset:57792
    ds_read_b128 v[92:95], v36 offset:57856
    ds_read_b128 v[96:99], v36 offset:57920
    ds_read_b128 v[100:103], v36 offset:57984
    ds_read_b128 v[104:107], v36 offset:58048
    s_waitcnt lgkmcnt(7)
    v_mfma_f32_16x16x32_bf16 v[108:111], v[44:47], v[76:79], 0
    s_waitcnt lgkmcnt(6)
    v_mfma_f32_16x16x32_bf16 v[108:111], v[48:51], v[80:83], v[108:111]
    s_waitcnt lgkmcnt(5)
    v_mfma_f32_16x16x32_bf16 v[108:111], v[52:55], v[84:87], v[108:111]
    s_waitcnt lgkmcnt(4)
    v_mfma_f32_16x16x32_bf16 v[108:111], v[56:59], v[88:91], v[108:111]
    s_waitcnt lgkmcnt(3)
    v_mfma_f32_16x16x32_bf16 v[108:111], v[60:63], v[92:95], v[108:111]
    s_waitcnt lgkmcnt(2)
    v_mfma_f32_16x16x32_bf16 v[108:111], v[64:67], v[96:99], v[108:111]
    s_waitcnt lgkmcnt(1)
    v_mfma_f32_16x16x32_bf16 v[108:111], v[68:71], v[100:103], v[108:111]
    s_waitcnt lgkmcnt(0)
    v_mfma_f32_16x16x32_bf16 v[108:111], v[72:75], v[104:107], v[108:111]
    s_nop 7
    v_cndmask_b32 v38, v108, v110, s[42:43]
    v_cndmask_b32 v40, v109, v111, s[42:43]
    s_mov_b32 exec_lo, 0x30003
    s_mov_b32 exec_hi, 0x30003
    buffer_store_dwordx4 v[38:41], v37, s[16:19], s47 offen offset:0
    s_add_u32 s47, s47, 65536
    buffer_store_dwordx4 v[38:41], v37, s[16:19], s47 offen offset:0 sc1
    s_mov_b64 exec, -1
    s_cmp_eq_u32 s39, 0
    s_cbranch_scc1 L_P4
    s_lshl_b32 s10, s3, 13
    s_add_u32 m0, s10, 8192
    s_add_u32 s8, s46, 0
    buffer_load_dwordx4 v42, s[24:27], s8 offen offset:0  lds
    s_add_u32 s8, s46, 48128
    buffer_load_dwordx4 v42, s[24:27], s8 offen offset:1024  lds
    s_add_u32 s8, s46, 96256
    buffer_load_dwordx4 v42, s[24:27], s8 offen offset:2048  lds
    s_add_u32 s8, s46, 144384
    buffer_load_dwordx4 v42, s[24:27], s8 offen offset:3072  lds
    s_add_u32 m0, s10, 12288
    s_add_u32 s8, s46, 196608
    buffer_load_dwordx4 v42, s[24:27], s8 offen offset:0  lds
    s_add_u32 s8, s46, 244736
    buffer_load_dwordx4 v42, s[24:27], s8 offen offset:1024  lds
    s_add_u32 s8, s46, 292864
    buffer_load_dwordx4 v42, s[24:27], s8 offen offset:2048  lds
    s_add_u32 s8, s46, 340992
    buffer_load_dwordx4 v42, s[24:27], s8 offen offset:3072  lds
    s_xor_b32 s8, s4, 1
    s_lshl_b32 s8, s8, 11
    s_add_u32 s8, s8, 524288
    v_lshlrev_b32 v14, 7, v3
    buffer_load_dword v14, v14, s[16:19], s8 offen sc1
    s_load_dwordx2 s[20:21], s[0:1], 48
    s_load_dwordx2 s[24:25], s[0:1], 56
    s_load_dwordx2 s[28:29], s[0:1], 64
    s_mov_b32 s22, 1835008
    s_mov_b32 s26, 1835008
    s_mov_b32 s30, 1835008
    s_lshl_b32 s10, s49, 2
    s_add_u32 s10, s10, s3
    s_mul_i32 s8, s10, 57344
    s_mul_i32 s9, s4, 7
    s_lshr_b32 s9, s9, 1
    s_lshl_b32 s9, s9, 7
    s_add_u32 s8, s8, s9
    v_bfe_u32 v6, v1, 2, 4
    v_mul_u32_u24 v6, 3584, v6
    v_and_b32 v7, 3, v1
    v_lshl_add_u32 v6, v7, 7, v6
    v_add_u32 v15, s8, v6
    s_lshr_b32 s8, s4, 2
    s_lshl_b32 s8, s8, 14
    s_lshl_b32 s9, s50, 9
    s_add_u32 s8, s8, s9
    s_add_u32 s13, s8, 409600
    s_waitcnt vmcnt(0) lgkmcnt(0)
    s_barrier
    ds_read_b64_tr_b16 v[44:45], v35 offset:8192
    ds_read_b64_tr_b16 v[46:47], v35 offset:10240
    ds_read_b64_tr_b16 v[48:49], v35 offset:12288
    ds_read_b64_tr_b16 v[50:51], v35 offset:14336
    ds_read_b64_tr_b16 v[52:53], v35 offset:16384
    ds_read_b64_tr_b16 v[54:55], v35 offset:18432
    ds_read_b64_tr_b16 v[56:57], v35 offset:20480
    ds_read_b64_tr_b16 v[58:59], v35 offset:22528
    ds_read_b64_tr_b16 v[60:61], v35 offset:24576
    ds_read_b64_tr_b16 v[62:63], v35 offset:26624
    ds_read_b64_tr_b16 v[64:65], v35 offset:28672
    ds_read_b64_tr_b16 v[66:67], v35 offset:30720
    ds_read_b64_tr_b16 v[68:69], v35 offset:32768
    ds_read_b64_tr_b16 v[70:71], v35 offset:34816
    ds_read_b64_tr_b16 v[72:73], v35 offset:36864
    ds_read_b64_tr_b16 v[74:75], v35 offset:38912
    ds_read_b128 v[76:79], v36 offset:56832
    ds_read_b128 v[80:83], v36 offset:56896
    ds_read_b128 v[84:87], v36 offset:56960
    ds_read_b128 v[88:91], v36 offset:57024
    ds_read_b128 v[92:95], v36 offset:57088
    ds_read_b128 v[96:99], v36 offset:57152
    ds_read_b128 v[100:103], v36 offset:57216
    ds_read_b128 v[104:107], v36 offset:57280
    s_waitcnt lgkmcnt(7)
    v_mfma_f32_16x16x32_bf16 v[108:111], v[44:47], v[76:79], 0
    s_waitcnt lgkmcnt(6)
    v_mfma_f32_16x16x32_bf16 v[108:111], v[48:51], v[80:83], v[108:111]
    s_waitcnt lgkmcnt(5)
    v_mfma_f32_16x16x32_bf16 v[108:111], v[52:55], v[84:87], v[108:111]
    s_waitcnt lgkmcnt(4)
    v_mfma_f32_16x16x32_bf16 v[108:111], v[56:59], v[88:91], v[108:111]
    s_waitcnt lgkmcnt(3)
    v_mfma_f32_16x16x32_bf16 v[108:111], v[60:63], v[92:95], v[108:111]
    s_waitcnt lgkmcnt(2)
    v_mfma_f32_16x16x32_bf16 v[108:111], v[64:67], v[96:99], v[108:111]
    s_waitcnt lgkmcnt(1)
    v_mfma_f32_16x16x32_bf16 v[108:111], v[68:71], v[100:103], v[108:111]
    s_waitcnt lgkmcnt(0)
    v_mfma_f32_16x16x32_bf16 v[108:111], v[72:75], v[104:107], v[108:111]
    s_nop 7
    v_cndmask_b32 v38, v108, v110, s[42:43]
    v_cndmask_b32 v40, v109, v111, s[42:43]
    s_mov_b32 exec_lo, 0x30003
    s_mov_b32 exec_hi, 0x30003
    buffer_store_dwordx4 v[38:41], v37, s[16:19], s13 offen offset:0 sc1
    s_mov_b64 exec, -1
    s_cmp_eq_u32 s36, 15
    s_cbranch_scc1 L_RED
    buffer_load_dword v16, v15, s[20:23], 0 offen
    s_mul_i32 s37, s4, 7
    s_and_b32 s12, s36, 7
    s_add_u32 s37, s37, s12
    v_lshlrev_b32 v6, 2, v2
    v_xor_b32 v6, v6, v3
    v_lshlrev_b32 v6, 4, v6
    v_lshl_or_b32 v18, v2, 10, v6
    s_lshl_b32 s41, s37, 15
    s_lshl_b32 s11, s3, 8
    s_add_u32 s41, s41, s11
    s_lshl_b32 s40, s3, 13
    s_add_u32 s40, s40, 8192
    s_barrier
    v_and_b32 v9, 1, v2
    v_lshlrev_b32 v6, 1, v9
    v_and_b32 v7, 3, v1
    v_xor_b32 v6, v6, v7
    v_lshrrev_b32 v10, 2, v1
    v_mul_u32_u24 v8, 3584, v10
    v_lshl_add_u32 v17, v6, 4, v8
    s_mul_i32 s39, s3, 458752
    s_lshl_b32 s9, s37, 6
    s_add_u32 s39, s39, s9
    s_lshl_b32 s38, s3, 14
    s_add_u32 s38, s38, 65536
    v_lshlrev_b32 v6, 5, v9
    v_lshl_or_b32 v6, v7, 3, v6
    v_lshl_or_b32 v6, v10, 6, v6
    v_add_u32 v192, s38, v6
    v_xor_b32 v193, 0x20, v192
    v_bfe_u32 v6, v1, 2, 2
    v_lshlrev_b32 v6, 6, v6
    v_lshl_or_b32 v6, v7, 4, v6
    v_lshl_or_b32 v6, v10, 8, v6
    v_add_u32 v194, s40, v6
    v_xor_b32 v195, 0x40, v194
    v_xor_b32 v196, 0x80, v194
    v_xor_b32 v197, 0xc0, v194
    v_lshlrev_b32 v6, 1, v2
    v_lshl_or_b32 v8, v3, 3, v6
    v_lshlrev_b32 v180, 1, v8
    v_lshlrev_b32 v186, 3, v8
    s_lshl_b32 s8, s3, 10
    s_add_u32 s43, s8, 475136
    buffer_load_dword v181, v180, s[32:35], s11 offen
    v_and_b32 v190, 0xffffffe3, v8
    v_bfe_u32 v6, v8, 2, 2
    v_lshl_or_b32 v190, v6, 3, v190
    v_bfe_u32 v6, v8, 4, 1
    v_lshl_or_b32 v190, v6, 2, v190
    v_lshlrev_b32 v190, 1, v190
    s_lshl_b32 s8, s3, 10
    v_add_u32 v190, s8, v190
    v_lshlrev_b32 v19, 4, v2
    v_min_u32 v6, 2, v7
    v_mul_u32_u24 v6, 320, v6
    v_add3_u32 v191, v6, v19, s8
    v_lshlrev_b32 v6, 3, v9
    v_xor_b32 v6, v6, v1
    v_lshl_add_u32 v198, v6, 4, s8
    v_lshrrev_b32 v8, 2, v3
    v_lshl_or_b32 v6, v2, 2, v7
    v_lshl_or_b32 v6, v8, 4, v6
    v_and_b32 v8, 1, v8
    v_lshlrev_b32 v8, 3, v8
    v_xor_b32 v6, v6, v8
    v_lshlrev_b32 v199, 4, v6
    v_lshlrev_b32 v6, 4, v3
    v_lshl_or_b32 v176, v2, 10, v6
    s_lshl_b32 s8, s4, 10
    s_add_u32 s8, s8, s11
    s_add_u32 s8, s8, 999424
    v_add_u32 v13, s8, v6
    s_and_b32 s47, s4, 3
    s_lshl_b32 s47, s47, 14
    s_add_u32 s47, s47, s11
    s_add_u32 s47, s47, 933888
    v_bfe_u32 v11, v1, 1, 1
    v_and_b32 v8, 1, v1
    v_lshl_add_u32 v178, v8, 6, v19
    v_lshl_add_u32 v6, v11, 14, v178
    v_bfe_u32 v8, v1, 2, 1
    v_lshl_add_u32 v200, v8, 13, v6
    s_and_b32 s9, s4, 1
    v_xor_b32 v11, s9, v11
    v_or_b32 v11, v11, v8
    v_lshl_or_b32 v178, v11, 29, v178
    v_bfe_u32 v6, v1, 3, 1
    v_xor_b32 v6, s9, v6
    v_and_b32 v8, 127, v180
    v_lshl_or_b32 v202, v6, 29, v8
    s_lshl_b32 s8, s4, 10
    s_lshl_b32 s9, s12, 7
    s_add_u32 s9, s9, s8
    s_lshl_b32 s42, s3, 15
    s_add_u32 s42, s42, s9
    s_add_u32 s42, s42, 802816
    s_add_u32 s46, s9, 1007616
    s_add_u32 s44, s8, 1008512
    s_mul_i32 s45, s4, 17408
    s_add_u32 s45, s45, 803712
    s_lshr_b32 s8, s4, 1
    s_cmp_eq_u32 s8, s3
    s_cselect_b32 s46, s46, 0x10000000
    s_cselect_b32 s8, s12, 1
    s_cmp_eq_u32 s8, 0
    s_cselect_b32 s44, s44, 0x10000000
    s_cselect_b32 s45, s45, 0x10000000
    v_mov_b32 v201, 0x3b000000
    v_mov_b32 v8, -1
    s_mov_b32 s48, 0xffff0000
    s_mov_b32 s49, 0
    s_mov_b32 s50, 0
    s_mov_b32 s51, 0xffff
    s_mov_b32 s52, 0
    s_mov_b32 s53, 0xffff0000
    v_cmp_eq_u32 vcc, 0, v7
    s_nop 1
    v_cndmask_b32 v204, 0, v8, vcc
    v_cmp_eq_u32 vcc, 1, v7
    s_nop 1
    v_cndmask_b32 v205, 0, v8, vcc
    v_cmp_eq_u32 vcc, 2, v7
    s_nop 1
    v_cndmask_b32 v206, 0, v8, vcc
    v_cmp_eq_u32 vcc, 3, v7
    s_nop 1
    v_cndmask_b32 v207, 0, v8, vcc
    v_and_b32 v6, 1, v1
    v_lshlrev_b32 v6, 4, v6
    v_mov_b32 v7, 0x3f80
    v_lshlrev_b32 v6, v6, v7
    v_lshrrev_b32 v7, 2, v3
    v_cmp_eq_u32 vcc, 0, v7
    s_nop 1
    v_cndmask_b32 v172, 0, v6, vcc
    v_cmp_eq_u32 vcc, 1, v7
    s_nop 1
    v_cndmask_b32 v173, 0, v6, vcc
    v_cmp_eq_u32 vcc, 2, v7
    s_nop 1
    v_cndmask_b32 v174, 0, v6, vcc
    v_cmp_eq_u32 vcc, 3, v7
    s_nop 1
    v_cndmask_b32 v175, 0, v6, vcc
    v_xor_b32 v14, s6, v14
    v_cmp_eq_u32 vcc, 1, v14
    s_nop 0
    s_bcnt1_i32_b64 s8, vcc
    v_cmp_eq_u32 vcc, 2, v14
    s_nop 0
    s_bcnt1_i32_b64 s9, vcc
    s_cmp_gt_u32 s9, s8
    s_cselect_b32 s9, 1, 0
    s_getreg_b32 s8, hwreg(HW_REG_XCC_ID, 2, 1)
    s_xor_b32 s9, s9, s8
    s_lshl_b32 s9, s9, 13
    s_add_u32 s47, s47, s9
    v_add_u32 v176, s47, v176
    v_add_u32 v177, 4096, v176
    v_cmp_eq_u32 vcc, s4, v2
    s_sub_u32 s8, s4, 4
    s_nop 0
    v_cndmask_b32 v188, v176, v13, vcc
    v_cmp_eq_u32 vcc, s8, v2
    s_nop 1
    v_cndmask_b32 v189, v177, v13, vcc
    s_and_b32 s8, s4, 3
    s_lshl_b32 s8, s8, 10
    s_lshr_b32 s9, s9, 4
    s_add_u32 s8, s8, s9
    v_lshl_add_u32 v6, v3, 13, s8
    s_lshl_b32 s8, s4, 13
    v_mov_b32 v7, s8
    v_cmp_gt_u32 vcc, 8, v3
    s_nop 1
    v_cndmask_b32 v6, v7, v6, vcc
    v_add_u32 v217, 348164, v6
    buffer_load_dword v216, v217, s[16:19], 0 offen sc1
    s_waitcnt vmcnt(2)
    s_add_u32 m0, s38, 0
    s_add_u32 s10, s39, 0
    buffer_load_dwordx4 v17, s[20:23], s10 offen offset:0  lds
    s_add_u32 s10, s39, 56320
    buffer_load_dwordx4 v17, s[20:23], s10 offen offset:1024  lds
    s_add_u32 s10, s39, 112640
    buffer_load_dwordx4 v17, s[20:23], s10 offen offset:2048  lds
    s_add_u32 s10, s39, 168960
    buffer_load_dwordx4 v17, s[20:23], s10 offen offset:3072  lds
    s_add_u32 m0, s38, 4096
    s_add_u32 s10, s39, 229376
    buffer_load_dwordx4 v17, s[20:23], s10 offen offset:0  lds
    s_add_u32 s10, s39, 285696
    buffer_load_dwordx4 v17, s[20:23], s10 offen offset:1024  lds
    s_add_u32 s10, s39, 342016
    buffer_load_dwordx4 v17, s[20:23], s10 offen offset:2048  lds
    s_add_u32 s10, s39, 398336
    buffer_load_dwordx4 v17, s[20:23], s10 offen offset:3072  lds
    s_add_u32 m0, s38, 8192
    s_add_u32 s10, s39, 0
    buffer_load_dwordx4 v17, s[24:27], s10 offen offset:0  lds
    s_add_u32 s10, s39, 56320
    buffer_load_dwordx4 v17, s[24:27], s10 offen offset:1024  lds
    s_add_u32 s10, s39, 112640
    buffer_load_dwordx4 v17, s[24:27], s10 offen offset:2048  lds
    s_add_u32 s10, s39, 168960
    buffer_load_dwordx4 v17, s[24:27], s10 offen offset:3072  lds
    s_add_u32 m0, s38, 12288
    s_add_u32 s10, s39, 229376
    buffer_load_dwordx4 v17, s[24:27], s10 offen offset:0  lds
    s_add_u32 s10, s39, 285696
    buffer_load_dwordx4 v17, s[24:27], s10 offen offset:1024  lds
    s_add_u32 s10, s39, 342016
    buffer_load_dwordx4 v17, s[24:27], s10 offen offset:2048  lds
    s_add_u32 s10, s39, 398336
    buffer_load_dwordx4 v17, s[24:27], s10 offen offset:3072  lds
    s_add_u32 m0, s40, 0
    s_add_u32 s10, s41, 0
    buffer_load_dwordx4 v18, s[28:31], s10 offen offset:0  lds
    s_add_u32 s10, s41, 3072
    buffer_load_dwordx4 v18, s[28:31], s10 offen offset:1024  lds
    s_add_u32 s10, s41, 6144
    buffer_load_dwordx4 v18, s[28:31], s10 offen offset:2048  lds
    s_add_u32 s10, s41, 9216
    buffer_load_dwordx4 v18, s[28:31], s10 offen offset:3072  lds
    s_add_u32 m0, s40, 4096
    s_add_u32 s10, s41, 16384
    buffer_load_dwordx4 v18, s[28:31], s10 offen offset:0  lds
    s_add_u32 s10, s41, 19456
    buffer_load_dwordx4 v18, s[28:31], s10 offen offset:1024  lds
    s_add_u32 s10, s41, 22528
    buffer_load_dwordx4 v18, s[28:31], s10 offen offset:2048  lds
    s_add_u32 s10, s41, 25600
    buffer_load_dwordx4 v18, s[28:31], s10 offen offset:3072  lds
    buffer_load_dwordx4 v[182:185], v186, s[16:19], s43 offen sc1
    s_waitcnt vmcnt(25)
    s_mov_b32 s7, 0
    s_branch L_ck_chk_10
L_ck_retry_9:
    s_add_u32 s7, s7, 1
    s_cmp_gt_u32 s7, 1048576
    s_cbranch_scc1 L_ck_done_11
    buffer_load_dword v216, v217, s[16:19], 0 offen sc1
    s_waitcnt vmcnt(0)
L_ck_chk_10:
    v_cmp_ne_u32 vcc, s6, v216
    s_cbranch_vccnz L_ck_retry_9
L_ck_done_11:
    buffer_load_dwordx4 v[164:167], v188, s[16:19], 0 offen sc1
    buffer_load_dwordx4 v[168:171], v189, s[16:19], 0 offen sc1
    s_waitcnt vmcnt(19)
    ds_read_b64_tr_b16 v[20:21], v192 offset:0
    ds_read_b64_tr_b16 v[22:23], v192 offset:1024
    ds_read_b64_tr_b16 v[24:25], v192 offset:2048
    ds_read_b64_tr_b16 v[26:27], v192 offset:3072
    ds_read_b64_tr_b16 v[28:29], v192 offset:4096
    ds_read_b64_tr_b16 v[30:31], v192 offset:5120
    ds_read_b64_tr_b16 v[32:33], v192 offset:6144
    ds_read_b64_tr_b16 v[34:35], v192 offset:7168
    ds_read_b64_tr_b16 v[52:53], v193 offset:0
    ds_read_b64_tr_b16 v[54:55], v193 offset:1024
    ds_read_b64_tr_b16 v[56:57], v193 offset:2048
    ds_read_b64_tr_b16 v[58:59], v193 offset:3072
    ds_read_b64_tr_b16 v[60:61], v193 offset:4096
    ds_read_b64_tr_b16 v[62:63], v193 offset:5120
    ds_read_b64_tr_b16 v[64:65], v193 offset:6144
    ds_read_b64_tr_b16 v[66:67], v193 offset:7168
    s_waitcnt vmcnt(11)
    ds_read_b64_tr_b16 v[36:37], v192 offset:8192
    ds_read_b64_tr_b16 v[38:39], v192 offset:9216
    ds_read_b64_tr_b16 v[40:41], v192 offset:10240
    ds_read_b64_tr_b16 v[42:43], v192 offset:11264
    ds_read_b64_tr_b16 v[44:45], v192 offset:12288
    ds_read_b64_tr_b16 v[46:47], v192 offset:13312
    ds_read_b64_tr_b16 v[48:49], v192 offset:14336
    ds_read_b64_tr_b16 v[50:51], v192 offset:15360
    ds_read_b64_tr_b16 v[68:69], v193 offset:8192
    ds_read_b64_tr_b16 v[70:71], v193 offset:9216
    ds_read_b64_tr_b16 v[72:73], v193 offset:10240
    ds_read_b64_tr_b16 v[74:75], v193 offset:11264
    ds_read_b64_tr_b16 v[76:77], v193 offset:12288
    ds_read_b64_tr_b16 v[78:79], v193 offset:13312
    ds_read_b64_tr_b16 v[80:81], v193 offset:14336
    ds_read_b64_tr_b16 v[82:83], v193 offset:15360
    s_waitcnt vmcnt(3)
    ds_read_b64_tr_b16 v[84:85], v194 offset:0
    ds_read_b64_tr_b16 v[86:87], v194 offset:4096
    ds_read_b64_tr_b16 v[88:89], v194 offset:8
    ds_read_b64_tr_b16 v[90:91], v194 offset:4104
    ds_read_b64_tr_b16 v[92:93], v195 offset:0
    ds_read_b64_tr_b16 v[94:95], v195 offset:4096
    ds_read_b64_tr_b16 v[96:97], v195 offset:8
    ds_read_b64_tr_b16 v[98:99], v195 offset:4104
    ds_read_b64_tr_b16 v[100:101], v196 offset:0
    ds_read_b64_tr_b16 v[102:103], v196 offset:4096
    ds_read_b64_tr_b16 v[104:105], v196 offset:8
    ds_read_b64_tr_b16 v[106:107], v196 offset:4104
    ds_read_b64_tr_b16 v[108:109], v197 offset:0
    ds_read_b64_tr_b16 v[110:111], v197 offset:4096
    ds_read_b64_tr_b16 v[112:113], v197 offset:8
    ds_read_b64_tr_b16 v[114:115], v197 offset:4104
    s_waitcnt vmcnt(2)
    s_mov_b32 s7, 0
    s_branch L_mbf_chk_13
L_mbf_retry_12:
    s_add_u32 s7, s7, 1
    s_cmp_gt_u32 s7, 1048576
    s_cbranch_scc1 L_mbf_done_14
    buffer_load_dwordx4 v[182:185], v186, s[16:19], s43 offen sc1
    s_waitcnt vmcnt(0)
L_mbf_chk_13:
    v_cmp_ne_u32 vcc, s6, v185
    s_cbranch_vccnz L_mbf_retry_12
L_mbf_done_14:
    ds_write_b32 v190, v184 offset:320
    ds_write_b32 v190, v183 offset:640
    v_lshlrev_b32 v208, 16, v181
    v_and_b32 v209, 0xffff0000, v181
    v_lshlrev_b32 v210, 16, v182
    v_and_b32 v211, 0xffff0000, v182
    v_lshlrev_b32 v6, 16, v184
    v_and_b32 v7, 0xffff0000, v184
    v_pk_mul_f32 v[212:213], v[210:211], v[6:7]
    v_pk_mul_f32 v[214:215], v[208:209], v[6:7]
    s_waitcnt vmcnt(0) lgkmcnt(0)
    s_branch L_P5b
L_RED:
    v_and_b32 v10, 31, v1
    v_lshrrev_b32 v11, 5, v1
    v_lshlrev_b32 v6, 14, v11
    v_lshl_or_b32 v12, v10, 4, v6
    s_lshl_b32 s8, s3, 12
    s_lshl_b32 s10, s4, 9
    s_add_u32 s8, s8, s10
    s_add_u32 s12, s8, 409600
    s_add_u32 s13, s12, 32768
    s_waitcnt vmcnt(0)
    s_mov_b32 s7, 0
    s_mov_b64 vcc, -1
L_mb_retry_18:
    s_add_u32 s7, s7, 1
    s_cmp_gt_u32 s7, 1048576
    s_cbranch_scc1 L_mb_done_20
    s_mov_b64 exec, vcc
    buffer_load_dwordx4 v[116:119], v12, s[16:19], s12 offen sc1
    s_mov_b64 exec, -1
    s_waitcnt vmcnt(0)
L_mb_chk_19:
    v_xor_b32 v6, s6, v117
    v_bitop3_b32 v6, v6, v119, s6 bitop3:0xf6
    v_cmp_ne_u32 vcc, 0, v6
    s_cbranch_vccnz L_mb_retry_18
L_mb_done_20:
    s_cmp_eq_u32 s3, 2
    s_cselect_b32 s8, 1.0, 0
    v_permlane32_swap_b32 v116, v118
    v_add_f32 v116, v116, v118
    v_cvt_pk_bf16_f32 v116, 0, v116
    v_add_f32 v116, s8, v116
    v_mov_b32 v118, v116
    s_lshl_b32 s8, s3, 2
    v_lshlrev_b32 v7, 4, v10
    v_add_u32 v6, s8, v7
    v_permlane32_swap_b32 v116, v118
    v_cvt_pk_bf16_f32 v116, v116, v118
    ds_write_b32 v6, v116 offset:58112
    s_waitcnt lgkmcnt(0)
    s_barrier
    s_cmp_lg_u32 s3, 1
    s_cbranch_scc1 L_redskip
    ds_read_b128 v[116:119], v7 offset:58112
    s_add_u32 s8, s10, 475136
    s_waitcnt lgkmcnt(0)
    v_mov_b32 v119, s6
    s_mov_b32 exec_lo, 0xffffffff
    s_mov_b32 exec_hi, 0x0
    buffer_store_dwordx4 v[116:119], v7, s[16:19], s8 offen sc1
    s_mov_b64 exec, -1
L_redskip:
    buffer_load_dword v16, v15, s[20:23], 0 offen
    s_cmp_lt_u32 s3, 2
    s_cbranch_scc1 L_fin6
    s_load_dwordx2 s[32:33], s[0:1], 88
    s_and_b32 s12, s3, 1
    s_lshl_b32 s12, s12, 6
    v_and_b32 v6, 3, v1
    v_lshl_add_u32 v8, v6, 4, s12
    v_lshl_add_u32 v158, v2, 2, v8
    v_lshlrev_b32 v7, 2, v158
    ds_read_b32 v162, v7 offset:58124
    v_and_b32 v6, 7, v1
    v_lshlrev_b32 v177, 9, v6
    s_mov_b32 s13, 475136
    v_bfe_u32 v6, v1, 2, 3
    v_lshl_add_u32 v8, v6, 7, v8
    v_add_u32 v6, 1, v6
    v_lshrrev_b32 v6, 3, v6
    v_lshl_or_b32 v165, v6, 29, v8
    v_lshrrev_b32 v6, 5, v1
    v_xor_b32 v6, s4, v6
    v_and_b32 v6, 1, v6
    v_lshl_add_u32 v164, v6, 10, v165
    v_and_b32 v6, 1, v1
    v_lshlrev_b32 v6, 4, v6
    v_mov_b32 v7, 0x3f80
    v_lshlrev_b32 v6, v6, v7
    v_lshrrev_b32 v7, 2, v3
    v_cmp_eq_u32 vcc, 0, v7
    s_nop 1
    v_cndmask_b32 v168, 0, v6, vcc
    v_cmp_eq_u32 vcc, 1, v7
    s_nop 1
    v_cndmask_b32 v169, 0, v6, vcc
    v_cmp_eq_u32 vcc, 2, v7
    s_nop 1
    v_cndmask_b32 v170, 0, v6, vcc
    v_cmp_eq_u32 vcc, 3, v7
    s_nop 1
    v_cndmask_b32 v171, 0, v6, vcc
    s_mov_b32 s7, 0
L_all_retry_21:
    s_add_u32 s7, s7, 1
    s_cmp_gt_u32 s7, 1048576
    s_cbranch_scc1 L_all_done_23
    buffer_load_dword v176, v177, s[16:19], s13 offen offset:12 sc1
    s_waitcnt vmcnt(0)
L_all_chk_22:
    v_cmp_ne_u32 vcc, s6, v176
    s_cbranch_vccnz L_all_retry_21
L_all_done_23:
    v_xor_b32 v14, s6, v14
    v_cmp_eq_u32 vcc, 1, v14
    s_nop 0
    s_bcnt1_i32_b64 s8, vcc
    v_cmp_eq_u32 vcc, 2, v14
    s_nop 0
    s_bcnt1_i32_b64 s9, vcc
    s_cmp_gt_u32 s9, s8
    s_cselect_b32 s9, 1, 0
    s_getreg_b32 s8, hwreg(HW_REG_XCC_ID, 2, 1)
    s_xor_b32 s9, s9, s8
    s_lshl_b32 s9, s9, 13
    s_lshl_b32 s8, s4, 14
    s_add_u32 s9, s9, s8
    s_add_u32 s9, s9, 802816
    s_and_b32 s10, s4, 6
    s_xor_b32 s8, s10, 0
    s_lshl_b32 s8, s8, 10
    s_add_u32 s55, s8, s9
    s_xor_b32 s8, s10, 2
    s_lshl_b32 s8, s8, 10
    s_add_u32 s56, s8, s9
    s_xor_b32 s8, s10, 4
    s_lshl_b32 s8, s8, 10
    s_add_u32 s57, s8, s9
    s_xor_b32 s8, s10, 6
    s_lshl_b32 s8, s8, 10
    s_add_u32 s58, s8, s9
    v_add_u32 v166, s55, v164
    s_lshl_b32 s8, s4, 10
    s_add_u32 s59, s8, 1007616
    s_add_u32 s55, s8, s9
    v_add_u32 v165, s59, v165
    v_cmp_gt_u32 vcc, 32, v1
    s_lshl_b32 s13, s4, 7
    s_waitcnt lgkmcnt(0)
    v_cndmask_b32 v165, v166, v165, vcc
    v_and_b32 v163, 0xffff0000, v162
    v_lshlrev_b32 v162, 16, v162
    s_mov_b32 s7, 0
    s_mov_b64 vcc, -1
L_fp_retry_24:
    s_add_u32 s7, s7, 1
    s_cmp_gt_u32 s7, 1048576
    s_cbranch_scc1 L_fp_done_26
    s_mov_b64 exec, vcc
    s_cmp_lg_u32 s7, 32
    s_cbranch_scc1 L_fploc
    v_mov_b32 v165, v166
    s_mov_b32 s59, s55
L_fploc:
    buffer_load_dword v159, v158, s[16:19], s59 offen offset:896 sc1
    buffer_load_dwordx4 v[116:119], v165, s[16:19], 0 offen sc1
    buffer_load_dwordx4 v[120:123], v164, s[16:19], s56 offen sc1
    buffer_load_dwordx4 v[124:127], v164, s[16:19], s57 offen sc1
    buffer_load_dwordx4 v[128:131], v164, s[16:19], s58 offen sc1
    s_mov_b64 exec, -1
    s_waitcnt vmcnt(3)
    v_mfma_f32_16x16x32_bf16 v[172:175], v[168:171], v[116:119], 0
    v_max3_u32 v10, v159, v116, v117
    v_max3_u32 v10, v10, v118, v119
    s_waitcnt vmcnt(2)
    v_mfma_f32_16x16x32_bf16 v[172:175], v[168:171], v[120:123], v[172:175]
    v_max3_u32 v10, v10, v120, v121
    v_max3_u32 v10, v10, v122, v123
    s_waitcnt vmcnt(1)
    v_mfma_f32_16x16x32_bf16 v[172:175], v[168:171], v[124:127], v[172:175]
    v_max3_u32 v10, v10, v124, v125
    v_max3_u32 v10, v10, v126, v127
    s_waitcnt vmcnt(0)
    v_mfma_f32_16x16x32_bf16 v[172:175], v[168:171], v[128:131], v[172:175]
    v_max3_u32 v10, v10, v128, v129
    v_max3_u32 v10, v10, v130, v131
    v_cmp_eq_u32 vcc, -1, v10
    v_lshlrev_b32 v160, 16, v159
    v_and_b32 v161, 0xffff0000, v159
L_fp_chk_25:
    s_cbranch_vccnz L_fp_retry_24
L_fp_done_26:
    s_nop 1
    v_add_f32_dpp v172, v172, v172 row_ror:4 row_mask:0xf bank_mask:0xf
    v_add_f32_dpp v173, v173, v173 row_ror:4 row_mask:0xf bank_mask:0xf
    s_nop 0
    v_add_f32_dpp v172, v172, v172 row_ror:8 row_mask:0xf bank_mask:0xf
    v_add_f32_dpp v173, v173, v173 row_ror:8 row_mask:0xf bank_mask:0xf
    s_mov_b32 exec_lo, 0xf000f
    s_mov_b32 exec_hi, 0xf000f
    v_pk_fma_f32 v[172:173], v[172:173], v[162:163], v[160:161]
    v_cvt_pk_bf16_f32 v6, v172, v173
    buffer_store_dword v6, v158, s[32:35], s13 offen nt
    s_mov_b64 exec, -1
L_fin6:
    s_endpgm
L_P4:
    s_load_dwordx2 s[20:21], s[0:1], 32
    s_lshl_b32 s8, s36, 2
    s_add_u32 s8, s8, s3
    s_and_b32 s9, s8, 24
    s_add_u32 s8, s8, s9
    s_lshl_b32 s8, s8, 13
    s_lshl_b32 s9, s4, 19
    s_add_u32 s8, s8, s9
    v_lshl_add_u32 v15, v1, 7, s8
    s_mov_b32 s8, 65536
    s_waitcnt lgkmcnt(0)
    s_lshl_b32 s13, s4, 13
    s_add_u32 s13, s13, 278528
    v_and_b32 v12, 7, v1
    v_lshlrev_b32 v12, 9, v12
    s_mov_b32 s7, 0
L_qs_retry_27:
    s_add_u32 s7, s7, 1
    s_cmp_gt_u32 s7, 1048576
    s_cbranch_scc1 L_qs_done_29
    s_cmp_eq_u32 s7, 32
    s_cselect_b32 s10, -1, 0
    s_and_b32 s11, s10, 65536
    s_add_u32 s13, s13, s11
    buffer_load_dword v13, v12, s[16:19], s13 offen offset:4 sc1
    s_waitcnt vmcnt(0)
L_qs_chk_28:
    v_cmp_ne_u32 vcc, s6, v13
    s_cbranch_vccnz L_qs_retry_27
L_qs_done_29:
    buffer_load_dword v16, v15, s[20:23], 0 offen
    s_lshl_b32 s12, s36, 7
    s_lshl_b32 s56, s4, 2
    s_add_u32 s56, s56, s3
    s_lshl_b32 s56, s56, 17
    s_add_u32 s56, s56, s12
    s_lshl_b32 s57, s3, 14
    s_add_u32 s57, s57, 65536
    v_lshl_or_b32 v158, v18, 10, v17
    v_bfe_u32 v6, v1, 3, 2
    v_lshlrev_b32 v6, 5, v6
    v_and_b32 v7, 3, v1
    v_lshl_or_b32 v6, v7, 3, v6
    v_lshrrev_b32 v7, 2, v1
    v_lshl_or_b32 v6, v7, 7, v6
    v_add_u32 v160, s57, v6
    v_xor_b32 v161, 0x20, v160
    v_xor_b32 v162, 0x40, v160
    v_xor_b32 v163, 0x60, v160
    v_lshlrev_b32 v164, 7, v7
    v_lshlrev_b32 v170, 7, v3
    v_lshl_or_b32 v170, v2, 4, v170
    s_lshl_b32 s58, s4, 11
    s_lshl_b32 s8, s3, 3
    s_add_u32 s58, s58, s8
    s_add_u32 s58, s58, 442368
    v_and_b32 v6, 3, v1
    v_xor_b32 v6, v6, v2
    v_lshlrev_b32 v6, 4, v6
    v_lshl_or_b32 v165, v7, 7, v6
    v_lshrrev_b32 v6, 2, v3
    v_xor_b32 v6, v6, v2
    v_lshl_or_b32 v6, v3, 2, v6
    s_lshl_b32 s8, s3, 12
    s_add_u32 s8, s8, 8192
    v_lshl_add_u32 v166, v6, 4, s8
    s_lshl_b32 s59, s4, 15
    s_lshr_b32 s9, s3, 1
    s_lshl_b32 s8, s9, 14
    s_add_u32 s59, s59, s8
    s_and_b32 s10, s3, 1
    s_lshl_b32 s8, s10, 6
    s_add_u32 s59, s59, s8
    s_add_u32 s59, s59, 540672
    s_lshl_b32 s8, s4, 10
    s_add_u32 s8, s8, s12
    s_add_u32 s62, s8, 999424
    s_cmp_eq_u32 s3, 0
    s_cselect_b32 s62, s62, 2147479552
    s_lshl_b32 s61, s3, 14
    s_add_u32 s61, s61, s8
    s_add_u32 s61, s61, 933888
    v_and_b32 v6, 31, v1
    v_lshrrev_b32 v7, 5, v1
    v_lshlrev_b32 v7, 13, v7
    v_lshl_or_b32 v169, v6, 2, v7
    v_lshlrev_b32 v6, 3, v6
    v_add_u32 v168, 58112, v6
    v_and_b32 v6, 1, v2
    v_lshrrev_b32 v7, 1, v2
    v_lshl_or_b32 v6, v6, 1, v7
    v_lshl_or_b32 v6, v6, 4, v3
    s_lshl_b32 s8, s3, 8
    s_add_u32 s8, s8, 58112
    v_lshl_add_u32 v167, v6, 2, s8
    s_waitcnt vmcnt(0)
    s_add_u32 m0, s57, 0
    s_add_u32 s8, s56, 0
    buffer_load_dwordx4 v158, s[20:23], s8 offen offset:0  lds
    s_add_u32 s8, s56, 7168
    buffer_load_dwordx4 v158, s[20:23], s8 offen offset:1024  lds
    s_add_u32 s8, s56, 14336
    buffer_load_dwordx4 v158, s[20:23], s8 offen offset:2048  lds
    s_add_u32 s8, s56, 21504
    buffer_load_dwordx4 v158, s[20:23], s8 offen offset:3072  lds
    s_add_u32 m0, s57, 4096
    s_add_u32 s8, s56, 32768
    buffer_load_dwordx4 v158, s[20:23], s8 offen offset:0  lds
    s_add_u32 s8, s56, 39936
    buffer_load_dwordx4 v158, s[20:23], s8 offen offset:1024  lds
    s_add_u32 s8, s56, 47104
    buffer_load_dwordx4 v158, s[20:23], s8 offen offset:2048  lds
    s_add_u32 s8, s56, 54272
    buffer_load_dwordx4 v158, s[20:23], s8 offen offset:3072  lds
    s_add_u32 m0, s57, 8192
    s_add_u32 s8, s56, 65536
    buffer_load_dwordx4 v158, s[20:23], s8 offen offset:0  lds
    s_add_u32 s8, s56, 72704
    buffer_load_dwordx4 v158, s[20:23], s8 offen offset:1024  lds
    s_add_u32 s8, s56, 79872
    buffer_load_dwordx4 v158, s[20:23], s8 offen offset:2048  lds
    s_add_u32 s8, s56, 87040
    buffer_load_dwordx4 v158, s[20:23], s8 offen offset:3072  lds
    s_add_u32 m0, s57, 12288
    s_add_u32 s8, s56, 98304
    buffer_load_dwordx4 v158, s[20:23], s8 offen offset:0  lds
    s_add_u32 s8, s56, 105472
    buffer_load_dwordx4 v158, s[20:23], s8 offen offset:1024  lds
    s_add_u32 s8, s56, 112640
    buffer_load_dwordx4 v158, s[20:23], s8 offen offset:2048  lds
    s_add_u32 s8, s56, 119808
    buffer_load_dwordx4 v158, s[20:23], s8 offen offset:3072  lds
    s_waitcnt vmcnt(12)
    ds_read_b64_tr_b16 v[18:19], v160 offset:0
    ds_read_b64_tr_b16 v[20:21], v160 offset:2048
    ds_read_b64_tr_b16 v[22:23], v161 offset:0
    ds_read_b64_tr_b16 v[24:25], v161 offset:2048
    ds_read_b64_tr_b16 v[26:27], v162 offset:0
    ds_read_b64_tr_b16 v[28:29], v162 offset:2048
    ds_read_b64_tr_b16 v[30:31], v163 offset:0
    ds_read_b64_tr_b16 v[32:33], v163 offset:2048
    s_waitcnt vmcnt(8)
    ds_read_b64_tr_b16 v[34:35], v160 offset:4096
    ds_read_b64_tr_b16 v[36:37], v160 offset:6144
    ds_read_b64_tr_b16 v[38:39], v161 offset:4096
    ds_read_b64_tr_b16 v[40:41], v161 offset:6144
    ds_read_b64_tr_b16 v[42:43], v162 offset:4096
    ds_read_b64_tr_b16 v[44:45], v162 offset:6144
    ds_read_b64_tr_b16 v[46:47], v163 offset:4096
    ds_read_b64_tr_b16 v[48:49], v163 offset:6144
    s_waitcnt vmcnt(4)
    ds_read_b64_tr_b16 v[50:51], v160 offset:8192
    ds_read_b64_tr_b16 v[52:53], v160 offset:10240
    ds_read_b64_tr_b16 v[54:55], v161 offset:8192
    ds_read_b64_tr_b16 v[56:57], v161 offset:10240
    ds_read_b64_tr_b16 v[58:59], v162 offset:8192
    ds_read_b64_tr_b16 v[60:61], v162 offset:10240
    ds_read_b64_tr_b16 v[62:63], v163 offset:8192
    ds_read_b64_tr_b16 v[64:65], v163 offset:10240
    s_waitcnt vmcnt(0)
    ds_read_b64_tr_b16 v[66:67], v160 offset:12288
    ds_read_b64_tr_b16 v[68:69], v160 offset:14336
    ds_read_b64_tr_b16 v[70:71], v161 offset:12288
    ds_read_b64_tr_b16 v[72:73], v161 offset:14336
    ds_read_b64_tr_b16 v[74:75], v162 offset:12288
    ds_read_b64_tr_b16 v[76:77], v162 offset:14336
    ds_read_b64_tr_b16 v[78:79], v163 offset:12288
    ds_read_b64_tr_b16 v[80:81], v163 offset:14336
    s_add_u32 s60, s59, 1024
    s_add_u32 s63, s59, 2048
    s_add_u32 s64, s59, 3072
    s_lshl_b32 s8, s3, 12
    s_add_u32 m0, s8, 8192
    buffer_load_dwordx2 v[82:83], v164, s[16:19], s58 offen sc1
    buffer_load_dwordx4 v165, s[16:19], s59 offen offset:0 sc1 lds
    buffer_load_dwordx4 v165, s[16:19], s60 offen offset:1024 sc1 lds
    buffer_load_dwordx4 v165, s[16:19], s63 offen offset:2048 sc1 lds
    buffer_load_dwordx4 v165, s[16:19], s64 offen offset:3072 sc1 lds
    s_branch L_P4b
L_P5b:
    s_mov_b32 s7, 0
    s_branch L_ap_chk_16
L_ap_retry_15:
    s_add_u32 s7, s7, 1
    s_cmp_gt_u32 s7, 1048576
    s_cbranch_scc1 L_ap_done_17
    s_mov_b64 exec, vcc
    s_cmp_lg_u32 s7, 32
    s_cbranch_scc1 L_aploc
    v_mov_b32 v188, v176
    v_mov_b32 v189, v177
L_aploc:
    buffer_load_dwordx4 v[164:167], v188, s[16:19], 0 offen sc1
    buffer_load_dwordx4 v[168:171], v189, s[16:19], 0 offen sc1
    s_mov_b64 exec, -1
    s_waitcnt vmcnt(0)
L_ap_chk_16:
    v_mfma_f32_16x16x32_bf16 v[148:151], v[172:175], v[164:167], 0
    v_mfma_f32_16x16x32_bf16 v[148:151], v[172:175], v[168:171], v[148:151]
    v_max_u32 v10, v164, v165
    v_max3_u32 v10, v10, v166, v167
    v_max3_u32 v10, v10, v168, v169
    v_max3_u32 v10, v10, v170, v171
    v_cmp_eq_u32 vcc, -1, v10
    s_cbranch_vccnz L_ap_retry_15
L_ap_done_17:
    s_nop 1
    v_pk_fma_f32 v[6:7], v[148:149], v[212:213], v[214:215]
    v_cvt_pk_bf16_f32 v6, v6, v7
    ds_write_b32 v190, v6 offset:0
    ds_read_b128 v[116:119], v191 offset:0
    ds_read_b128 v[120:123], v191 offset:64
    ds_read_b128 v[124:127], v191 offset:128
    ds_read_b128 v[128:131], v191 offset:192
    v_pk_fma_f32 v[8:9], v[148:149], v[210:211], v[208:209]
    v_cvt_pk_bf16_f32 v179, v8, v9
    buffer_store_dword v179, v202, s[16:19], s44 offen
L_nox1:
    v_add_f32 v167, v8, v9
    v_mul_f32 v10, v8, v8
    v_fmac_f32 v10, v9, v9
    s_waitcnt lgkmcnt(3)
    v_mfma_f32_16x16x32_bf16 v[148:151], v[116:119], v[20:23], 0
    s_waitcnt lgkmcnt(2)
    v_mfma_f32_16x16x32_bf16 v[148:151], v[120:123], v[24:27], v[148:151]
    v_permlane16_swap_b32 v167, v10
    s_waitcnt lgkmcnt(1)
    v_mfma_f32_16x16x32_bf16 v[148:151], v[124:127], v[28:31], v[148:151]
    v_add_f32 v167, v167, v10
    s_waitcnt lgkmcnt(0)
    v_mfma_f32_16x16x32_bf16 v[148:151], v[128:131], v[32:35], v[148:151]
    v_mov_b32 v10, v167
    v_mfma_f32_16x16x32_bf16 v[152:155], v[116:119], v[36:39], 0
    v_mfma_f32_16x16x32_bf16 v[152:155], v[120:123], v[40:43], v[152:155]
    v_permlane32_swap_b32 v167, v10
    v_mfma_f32_16x16x32_bf16 v[152:155], v[124:127], v[44:47], v[152:155]
    v_add_f32 v167, v167, v10
    v_mfma_f32_16x16x32_bf16 v[152:155], v[128:131], v[48:51], v[152:155]
    v_mfma_f32_16x16x32_bf16 v[156:159], v[116:119], v[52:55], 0
    v_add_f32_dpp v167, v167, v167 row_ror:8 row_mask:0xf bank_mask:0xf
    v_mfma_f32_16x16x32_bf16 v[156:159], v[120:123], v[56:59], v[156:159]
    v_mfma_f32_16x16x32_bf16 v[156:159], v[124:127], v[60:63], v[156:159]
    v_add_f32_dpp v167, v167, v167 row_ror:4 row_mask:0xf bank_mask:0xf
    v_mfma_f32_16x16x32_bf16 v[156:159], v[128:131], v[64:67], v[156:159]
    v_mfma_f32_16x16x32_bf16 v[160:163], v[116:119], v[68:71], 0
    v_add_f32_dpp v167, v167, v167 row_ror:2 row_mask:0xf bank_mask:0xf
    v_mfma_f32_16x16x32_bf16 v[160:163], v[120:123], v[72:75], v[160:163]
    v_mfma_f32_16x16x32_bf16 v[160:163], v[124:127], v[76:79], v[160:163]
    v_add_f32_dpp v167, v167, v167 row_ror:1 row_mask:0xf bank_mask:0xf
    v_mfma_f32_16x16x32_bf16 v[160:163], v[128:131], v[80:83], v[160:163]
    v_cndmask_b32 v164, v148, v152, s[48:49]
    v_cndmask_b32 v165, v149, v153, s[48:49]
    v_cndmask_b32 v166, v150, v154, s[48:49]
    v_cndmask_b32 v164, v164, v156, s[50:51]
    v_cndmask_b32 v165, v165, v157, s[50:51]
    v_cndmask_b32 v166, v166, v158, s[50:51]
    s_nop 1
    v_cndmask_b32 v164, v164, v160, s[52:53]
    v_cndmask_b32 v165, v165, v161, s[52:53]
    v_cndmask_b32 v166, v166, v162, s[52:53]
    ds_write_b128 v198, v[164:167] offset:4096
    s_waitcnt lgkmcnt(0)
    s_barrier
    ds_read_b128 v[116:119], v199 offset:4096
    ds_read_b128 v[120:123], v199 offset:5120
    ds_read_b128 v[124:127], v199 offset:6144
    ds_read_b128 v[128:131], v199 offset:7168
    s_waitcnt lgkmcnt(2)
    v_pk_add_f32 v[118:119], v[118:119], v[122:123]
    v_pk_add_f32 v[116:117], v[116:117], v[120:121]
    s_waitcnt lgkmcnt(0)
    v_pk_add_f32 v[126:127], v[126:127], v[130:131]
    v_pk_add_f32 v[118:119], v[118:119], v[126:127]
    v_mul_f32 v6, v119, v201
    v_mul_f32 v7, v119, v201
    v_pk_add_f32 v[124:125], v[124:125], v[128:129]
    v_mul_f32_dpp v6, v119, v201 row_ror:4 row_mask:0xf bank_mask:0xa
    v_mul_f32_dpp v7, v119, v201 row_ror:4 row_mask:0xf bank_mask:0x5
    v_fma_f32 v7, -v6, v6, v7
    v_max_f32 v7, 0, v7
    v_add_f32 v7, 0x3727c5ac, v7
    v_rsq_f32 v7, v7
    v_pk_add_f32 v[116:117], v[116:117], v[124:125]
    v_fma_f32 v6, -v6, v117, v116
    v_fma_f32 v6, v7, v6, v118
    v_mul_f32 v7, 0xbfb8aa3b, v6
    v_exp_f32 v7, v7
    v_mul_f32_dpp v8, v6, v6 row_shl:4 row_mask:0xf bank_mask:0xf
    v_add_f32 v7, 1.0, v7
    v_rcp_f32 v7, v7
    s_nop 0
    v_mul_f32 v8, v8, v7
    s_nop 1
    v_mov_b32_dpp v7, v8 quad_perm:[1,1,3,3] row_mask:0xf bank_mask:0xf
    v_cvt_pk_bf16_f32 v6, v8, v7
    s_nop 1
    v_and_b32_dpp v132, v6, v204 row_newbcast:0 row_mask:0xf bank_mask:0xf
    v_and_b32_dpp v133, v6, v204 row_newbcast:2 row_mask:0xf bank_mask:0xf
    v_and_b32_dpp v134, v6, v204 row_newbcast:8 row_mask:0xf bank_mask:0xf
    v_and_b32_dpp v135, v6, v204 row_newbcast:10 row_mask:0xf bank_mask:0xf
    v_and_b32_dpp v136, v6, v205 row_newbcast:0 row_mask:0xf bank_mask:0xf
    v_and_b32_dpp v137, v6, v205 row_newbcast:2 row_mask:0xf bank_mask:0xf
    v_mfma_f32_16x16x32_bf16 v[148:151], v[84:87], v[132:135], 0
    v_and_b32_dpp v138, v6, v205 row_newbcast:8 row_mask:0xf bank_mask:0xf
    v_and_b32_dpp v139, v6, v205 row_newbcast:10 row_mask:0xf bank_mask:0xf
    v_mfma_f32_16x16x32_bf16 v[152:155], v[88:91], v[132:135], 0
    v_and_b32_dpp v140, v6, v206 row_newbcast:0 row_mask:0xf bank_mask:0xf
    v_and_b32_dpp v141, v6, v206 row_newbcast:2 row_mask:0xf bank_mask:0xf
    v_mfma_f32_16x16x32_bf16 v[148:151], v[92:95], v[136:139], v[148:151]
    v_and_b32_dpp v142, v6, v206 row_newbcast:8 row_mask:0xf bank_mask:0xf
    v_and_b32_dpp v143, v6, v206 row_newbcast:10 row_mask:0xf bank_mask:0xf
    v_mfma_f32_16x16x32_bf16 v[152:155], v[96:99], v[136:139], v[152:155]
    v_and_b32_dpp v144, v6, v207 row_newbcast:0 row_mask:0xf bank_mask:0xf
    v_and_b32_dpp v145, v6, v207 row_newbcast:2 row_mask:0xf bank_mask:0xf
    v_mfma_f32_16x16x32_bf16 v[148:151], v[100:103], v[140:143], v[148:151]
    v_and_b32_dpp v146, v6, v207 row_newbcast:8 row_mask:0xf bank_mask:0xf
    v_and_b32_dpp v147, v6, v207 row_newbcast:10 row_mask:0xf bank_mask:0xf
    v_mfma_f32_16x16x32_bf16 v[152:155], v[104:107], v[140:143], v[152:155]
    s_nop 0
    v_mfma_f32_16x16x32_bf16 v[148:151], v[108:111], v[144:147], v[148:151]
    v_mfma_f32_16x16x32_bf16 v[152:155], v[112:115], v[144:147], v[152:155]
    s_mov_b32 exec_lo, 0xff00ff
    s_mov_b32 exec_hi, 0xff00ff
    s_nop 4
    v_cvt_pk_bf16_f32 v6, v148, v149
    v_cvt_pk_bf16_f32 v7, v150, v151
    v_cvt_pk_bf16_f32 v8, v152, v153
    v_cvt_pk_bf16_f32 v9, v154, v155
    buffer_store_dwordx4 v[6:9], v200, s[16:19], s42 offen sc1
    buffer_store_dwordx4 v[6:9], v178, s[16:19], s46 offen
    s_mov_b64 exec, -1
    buffer_store_dword v179, v202, s[16:19], s45 offen sc1
    s_add_u32 s45, s45, 8192
    buffer_store_dword v179, v202, s[16:19], s45 offen sc1
    s_or_b32 s8, s37, s3
    s_cbranch_scc1 L_noepoch
    s_mov_b64 exec, 1
    v_mov_b32 v18, s6
    buffer_store_dword v18, v180, s[16:19], 0 offen sc1
L_noepoch:
    s_mov_b64 exec, -1
    s_endpgm
L_P4b:
    s_mov_b32 s7, 0
    s_branch L_sweep_36
L_sweep_35:
    s_or_b32 s8, vcc_lo, vcc_hi
    s_lshr_b32 s9, s8, 16
    s_or_b32 s8, s8, s9
    s_bitreplicate_b64_b32 s[66:67], s8
    s_bitreplicate_b64_b32 s[66:67], s66
    s_or_b64 exec, s[66:67], s[68:69]
    buffer_load_dwordx2 v[82:83], v164, s[16:19], s58 offen sc1
    buffer_load_dwordx4 v165, s[16:19], s59 offen offset:0 sc1 lds
    buffer_load_dwordx4 v165, s[16:19], s60 offen offset:1024 sc1 lds
    buffer_load_dwordx4 v165, s[16:19], s63 offen offset:2048 sc1 lds
    buffer_load_dwordx4 v165, s[16:19], s64 offen offset:3072 sc1 lds
    s_mov_b64 exec, -1
L_sweep_36:
    s_waitcnt vmcnt(0)
    ds_read_b128 v[94:97], v166 offset:0
    ds_read_b128 v[98:101], v166 offset:1024
    ds_read_b128 v[102:105], v166 offset:2048
    ds_read_b128 v[106:109], v166 offset:3072
    s_waitcnt lgkmcnt(0)
    s_branch L_og_chk_31
L_ogfb_33:
    s_cmp_eq_u32 s7, 32
    s_cselect_b32 s10, -1, 0
    s_and_b32 s11, s10, 16384
    s_add_u32 s58, s58, s11
    s_and_b32 s11, s10, 8192
    s_add_u32 s59, s59, s11
    s_add_u32 s60, s60, s11
    s_add_u32 s63, s63, s11
    s_add_u32 s64, s64, s11
    s_cmp_gt_u32 s7, 1048576
    s_cbranch_scc1 L_og_done_32
    s_branch L_ogfb_34
L_og_retry_30:
    s_add_u32 s7, s7, 1
    s_cmp_ge_u32 s7, 32
    s_cbranch_scc1 L_ogfb_33
L_ogfb_34:
    s_bcnt1_i32_b64 s8, vcc
    s_cmp_gt_u32 s8, 8
    s_cbranch_scc1 L_sweep_35
    s_or_b64 exec, vcc, 1
    buffer_load_dwordx4 v[94:97], v170, s[16:19], s59 offen offset:0 sc1
    buffer_load_dwordx4 v[98:101], v170, s[16:19], s60 offen offset:1024 sc1
    buffer_load_dwordx4 v[102:105], v170, s[16:19], s63 offen offset:2048 sc1
    buffer_load_dwordx4 v[106:109], v170, s[16:19], s64 offen offset:3072 sc1
    s_or_b64 exec, s[68:69], 1
    buffer_load_dwordx2 v[82:83], v164, s[16:19], s58 offen sc1
    s_mov_b64 exec, -1
    s_waitcnt vmcnt(0)
L_og_chk_31:
    v_cmp_ne_u32 s[68:69], s6, v83
    v_mfma_f32_16x16x32_bf16 v[110:113], v[94:97], v[18:21], 0
    v_max_u32 v10, v94, v95
    v_max3_u32 v10, v10, v96, v97
    v_mfma_f32_16x16x32_bf16 v[110:113], v[98:101], v[34:37], v[110:113]
    v_max3_u32 v10, v10, v98, v99
    v_max3_u32 v10, v10, v100, v101
    v_mfma_f32_16x16x32_bf16 v[110:113], v[102:105], v[50:53], v[110:113]
    v_max3_u32 v10, v10, v102, v103
    v_max3_u32 v10, v10, v104, v105
    v_mfma_f32_16x16x32_bf16 v[110:113], v[106:109], v[66:69], v[110:113]
    v_max3_u32 v10, v10, v106, v107
    v_max3_u32 v10, v10, v108, v109
    v_cmp_eq_u32 vcc, -1, v10
    v_max_f32_dpp v84, v82, v82 row_ror:4 row_mask:0xf bank_mask:0xf
    s_or_b64 s[66:67], vcc, s[68:69]
    s_cbranch_scc1 L_og_retry_30
L_og_done_32:
    v_mfma_f32_16x16x32_bf16 v[114:117], v[94:97], v[22:25], 0
    v_max_f32_dpp v84, v84, v84 row_ror:8 row_mask:0xf bank_mask:0xf
    v_mov_b32 v87, v84
    v_mfma_f32_16x16x32_bf16 v[114:117], v[98:101], v[38:41], v[114:117]
    v_mfma_f32_16x16x32_bf16 v[114:117], v[102:105], v[54:57], v[114:117]
    v_permlane16_swap_b32 v84, v87
    v_max_f32 v84, v84, v87
    v_mov_b32 v87, v84
    v_mfma_f32_16x16x32_bf16 v[114:117], v[106:109], v[70:73], v[114:117]
    v_mfma_f32_16x16x32_bf16 v[118:121], v[94:97], v[26:29], 0
    v_permlane32_swap_b32 v84, v87
    v_max_f32 v84, v84, v87
    v_sub_f32 v86, v82, v84
    v_mfma_f32_16x16x32_bf16 v[118:121], v[98:101], v[42:45], v[118:121]
    v_exp_f32 v86, v86
    v_mfma_f32_16x16x32_bf16 v[118:121], v[102:105], v[58:61], v[118:121]
    v_mfma_f32_16x16x32_bf16 v[118:121], v[106:109], v[74:77], v[118:121]
    v_mov_b32_dpp v90, v86 row_newbcast:0 row_mask:0xf bank_mask:0xf
    v_mov_b32_dpp v91, v86 row_newbcast:4 row_mask:0xf bank_mask:0xf
    v_mfma_f32_16x16x32_bf16 v[122:125], v[94:97], v[30:33], 0
    v_mov_b32_dpp v92, v86 row_newbcast:8 row_mask:0xf bank_mask:0xf
    v_mov_b32_dpp v93, v86 row_newbcast:12 row_mask:0xf bank_mask:0xf
    v_mfma_f32_16x16x32_bf16 v[122:125], v[98:101], v[46:49], v[122:125]
    v_add_f32_dpp v85, v86, v86 row_ror:4 row_mask:0xf bank_mask:0xf
    v_pk_mul_f32 v[6:7], v[110:111], v[90:91]
    v_mfma_f32_16x16x32_bf16 v[122:125], v[102:105], v[62:65], v[122:125]
    v_pk_fma_f32 v[6:7], v[112:113], v[92:93], v[6:7]
    v_add_f32_dpp v85, v85, v85 row_ror:8 row_mask:0xf bank_mask:0xf
    v_mfma_f32_16x16x32_bf16 v[122:125], v[106:109], v[78:81], v[122:125]
    v_mov_b32 v87, v85
    v_add_f32 v126, v6, v7
    v_pk_mul_f32 v[8:9], v[114:115], v[90:91]
    v_permlane16_swap_b32 v85, v87
    v_add_f32 v85, v85, v87
    v_mov_b32 v87, v85
    v_pk_fma_f32 v[8:9], v[116:117], v[92:93], v[8:9]
    v_add_f32 v127, v8, v9
    v_permlane32_swap_b32 v85, v87
    v_add_f32 v85, v85, v87
    v_rcp_f32 v85, v85
    v_permlane32_swap_b32 v126, v127
    v_add_f32 v126, v126, v127
    v_pk_mul_f32 v[6:7], v[118:119], v[90:91]
    v_pk_fma_f32 v[6:7], v[120:121], v[92:93], v[6:7]
    v_add_f32 v128, v6, v7
    v_pk_mul_f32 v[8:9], v[122:123], v[90:91]
    v_pk_fma_f32 v[8:9], v[124:125], v[92:93], v[8:9]
    v_add_f32 v129, v8, v9
    s_nop 1
    v_permlane32_swap_b32 v128, v129
    v_add_f32 v128, v128, v129
    s_nop 1
    v_permlane16_swap_b32 v126, v128
    v_add_f32 v126, v126, v128
    v_mul_f32 v126, v126, v85
    ds_write_b32 v167, v126
    s_waitcnt lgkmcnt(0)
    s_barrier
    ds_read2_b64 v[6:9], v168 offset0:0 offset1:32
    ds_read2_b64 v[10:13], v168 offset0:64 offset1:96
    s_waitcnt lgkmcnt(1)
    v_pk_add_f32 v[6:7], v[6:7], v[8:9]
    s_waitcnt lgkmcnt(0)
    v_pk_add_f32 v[10:11], v[10:11], v[12:13]
    v_pk_add_f32 v[6:7], v[6:7], v[10:11]
    v_cvt_pk_bf16_f32 v6, v6, v7
    buffer_store_dword v6, v169, s[16:19], s61 offen sc1
    s_mov_b32 exec_hi, 0
    buffer_store_dword v6, v169, s[16:19], s62 offen
    s_mov_b64 exec, -1
    s_endpgm
L_A:
    s_add_u32 m0, s41, 0
    s_nop 0
    buffer_load_dwordx4 v18, s[24:27], s37 offen offset:0 nt lds
    buffer_load_dwordx4 v19, s[24:27], s37 offen offset:1024 nt lds
    buffer_load_dwordx4 v20, s[24:27], s37 offen offset:2048 nt lds
    buffer_load_dwordx4 v21, s[24:27], s37 offen offset:3072 nt lds
    s_mov_b32 s18, 1015808
    s_mov_b32 s19, 0x20000
    s_load_dwordx2 s[20:21], s[0:1], 56
    s_load_dwordx2 s[32:33], s[0:1], 64
    s_mov_b32 s22, 1835008
    s_mov_b32 s34, 1835008
    s_mov_b32 s35, 0x20000
    s_lshl_b32 s8, s4, 6
    s_add_u32 s8, s8, s44
    s_mul_i32 s8, s8, 3584
    v_and_b32 v25, 31, v1
    v_min_u32 v25, 27, v25
    v_lshl_add_u32 v25, v25, 7, s8
    s_lshl_b32 s48, s4, 15
    s_lshl_b32 s46, s4, 3
    s_add_u32 s46, s46, s3
    s_lshl_b32 s46, s46, 10
    s_add_u32 s46, s46, 278528
    s_add_u32 s47, s46, 4096
    s_mul_i32 s8, s3, 320
    s_add_u32 s8, s8, 133120
    v_lshl_add_u32 v34, v1, 2, s8
    v_and_b32 v8, 3, v1
    v_mul_u32_u24 v6, 320, v8
    v_lshl_add_u32 v6, v2, 4, v6
    v_add_u32 v35, 133120, v6
    v_lshlrev_b32 v6, 4, v8
    v_lshlrev_b32 v41, 1, v6
    v_add_u32 v41, 134400, v41
    s_lshl_b32 s8, s3, 3
    v_lshrrev_b32 v7, 5, v1
    v_lshl_add_u32 v7, v7, 2, s8
    v_add_u32 v40, v7, v41
    v_lshlrev_b32 v50, 2, v6
    v_add_u32 v50, 134528, v50
    s_lshl_b32 s8, s3, 4
    v_and_b32 v7, 12, v1
    v_add3_u32 v49, v7, v50, s8
    v_mov_b32 v52, 0x3db504f3
    v_mov_b32 v53, 0x3db504f3
    v_lshl_add_u32 v6, v2, 6, v6
    v_add_u32 v39, 131072, v6
    s_lshr_b32 s8, s3, 1
    s_lshl_b32 s8, s8, 8
    s_and_b32 s9, s3, 1
    s_lshl_b32 s9, s9, 3
    s_add_u32 s8, s8, s9
    v_lshrrev_b32 v7, 2, v3
    v_lshl_add_u32 v7, v7, 9, v39
    v_add_u32 v38, s8, v7
    s_lshl_b32 s8, s3, 1
    v_bfe_u32 v6, v1, 2, 3
    v_xor_b32 v6, s8, v6
    v_lshlrev_b32 v6, 5, v6
    v_lshl_or_b32 v6, v8, 3, v6
    v_lshrrev_b32 v9, 2, v1
    v_lshl_or_b32 v6, v9, 8, v6
    v_add_u32 v36, 65536, v6
    v_xor_b32 v37, 0x20, v36
    s_lshl_b32 s8, s3, 11
    s_lshl_b32 s9, s5, 7
    s_add_u32 s48, s48, s8
    s_add_u32 s48, s48, s9
    s_add_u32 s48, s48, 540672
    v_bfe_u32 v6, v1, 1, 1
    v_lshlrev_b32 v6, 14, v6
    v_and_b32 v7, 1, v1
    v_lshl_or_b32 v6, v7, 6, v6
    v_lshl_or_b32 v42, v2, 4, v6
    v_lshlrev_b32 v6, 3, v3
    v_lshl_or_b32 v48, v2, 29, v6
    s_lshl_b32 s8, s4, 11
    s_add_u32 s8, s8, s9
    s_add_u32 s8, s8, 442368
    s_cmp_eq_u32 s3, 0
    s_cselect_b32 s49, s8, 0x10000000
    s_load_dwordx2 s[64:65], s[0:1], 32
    s_mov_b32 s66, 4194304
    s_mov_b32 s67, 0x20000
    s_mov_b32 s68, 0
    s_and_b32 s8, s44, 48
    s_add_u32 s8, s8, s44
    s_add_u32 s8, s8, 16
    s_lshl_b32 s8, s8, 12
    s_lshl_b32 s9, s4, 19
    s_add_u32 s8, s8, s9
    v_and_b32 v26, 31, v1
    v_lshl_add_u32 v26, v26, 7, s8
    v_mov_b32 v44, 0x3f803f80
    v_mov_b32 v45, 0x3f803f80
    v_mov_b32 v46, 0x3f803f80
    v_mov_b32 v47, 0x3f803f80
    s_mov_b32 s50, 0xf000f0
    s_mov_b32 s51, 0xf000f0
    s_mov_b32 s52, 0xf000f00
    s_mov_b32 s53, 0xf000f00
    s_mov_b32 s54, 0xf000f000
    s_mov_b32 s55, 0xf000f000
    s_mul_i32 s8, s44, 28672
    s_mul_i32 s9, s4, 7
    s_lshr_b32 s9, s9, 1
    s_lshl_b32 s9, s9, 7
    s_add_u32 s8, s8, s9
    v_bfe_u32 v6, v1, 2, 3
    v_mul_u32_u24 v6, 3584, v6
    v_and_b32 v7, 3, v1
    v_lshl_add_u32 v6, v7, 7, v6
    v_add_u32 v15, s8, v6
    s_add_u32 m0, s41, 4096
    s_waitcnt vmcnt(4)
    buffer_load_dwordx4 v18, s[24:27], s38 offen offset:0 nt lds
    buffer_load_dwordx4 v19, s[24:27], s38 offen offset:1024 nt lds
    buffer_load_dwordx4 v20, s[24:27], s38 offen offset:2048 nt lds
    buffer_load_dwordx4 v21, s[24:27], s38 offen offset:3072 nt lds
    s_add_u32 m0, s41, 8192
    s_waitcnt vmcnt(7)
    buffer_load_dwordx4 v18, s[24:27], s39 offen offset:0 nt lds
    s_waitcnt vmcnt(7)
    buffer_load_dwordx4 v19, s[24:27], s39 offen offset:1024 nt lds
    s_waitcnt vmcnt(7)
    buffer_load_dwordx4 v20, s[24:27], s39 offen offset:2048 nt lds
    s_waitcnt vmcnt(7)
    buffer_load_dwordx4 v21, s[24:27], s39 offen offset:3072 nt lds
    s_waitcnt vmcnt(8)
    ds_read_b128 v[62:65], v30 offset:0
    ds_read_b128 v[66:69], v31 offset:0
    ds_read_b128 v[70:73], v32 offset:0
    ds_read_b128 v[74:77], v33 offset:0
    s_add_u32 m0, s41, 12288
    s_waitcnt vmcnt(7)
    buffer_load_dwordx4 v18, s[24:27], s40 offen offset:0 nt lds
    s_waitcnt vmcnt(7)
    buffer_load_dwordx4 v19, s[24:27], s40 offen offset:1024 nt lds
    s_waitcnt vmcnt(7)
    buffer_load_dwordx4 v20, s[24:27], s40 offen offset:2048 nt lds
    s_waitcnt vmcnt(7)
    buffer_load_dwordx4 v21, s[24:27], s40 offen offset:3072 nt lds
    s_waitcnt vmcnt(8)
    ds_read_b128 v[78:81], v30 offset:4096
    ds_read_b128 v[82:85], v31 offset:4096
    ds_read_b128 v[86:89], v32 offset:4096
    ds_read_b128 v[90:93], v33 offset:4096
    s_add_u32 m0, s42, 0
    s_waitcnt vmcnt(7)
    buffer_load_dwordx4 v22, s[28:31], s37 offen offset:0 nt lds
    s_waitcnt vmcnt(7)
    buffer_load_dwordx4 v23, s[28:31], s37 offen offset:1024 nt lds
    s_waitcnt vmcnt(7)
    buffer_load_dwordx4 v22, s[28:31], s37 offen offset:2048 nt lds
    s_waitcnt vmcnt(7)
    buffer_load_dwordx4 v23, s[28:31], s37 offen offset:3072 nt lds
    s_waitcnt vmcnt(8) lgkmcnt(0)
    ds_read_b128 v[94:97], v30 offset:8192
    ds_read_b128 v[98:101], v31 offset:8192
    ds_read_b128 v[102:105], v32 offset:8192
    ds_read_b128 v[106:109], v33 offset:8192
    s_mul_i32 s6, s6, 0x41c64e61
    s_add_u32 s6, s6, 0x3c6ef357
    s_bitset0_b32 s6, 31
    s_mov_b32 s60, 0
    s_add_u32 s8, s46, s60
    s_add_u32 s9, s47, s60
    s_load_dword s56, s[16:17], s8 offset:4
    s_load_dword s57, s[16:17], s8 offset:516
    s_load_dword s58, s[16:17], s9 offset:4
    s_load_dword s59, s[16:17], s9 offset:516
    s_add_u32 m0, s42, 16384
    s_waitcnt vmcnt(7)
    buffer_load_dwordx4 v22, s[28:31], s38 offen offset:0 nt lds
    s_waitcnt vmcnt(7)
    buffer_load_dwordx4 v23, s[28:31], s38 offen offset:1024 nt lds
    s_waitcnt vmcnt(7)
    buffer_load_dwordx4 v22, s[28:31], s38 offen offset:2048 nt lds
    s_waitcnt vmcnt(7)
    buffer_load_dwordx4 v23, s[28:31], s38 offen offset:3072 nt lds
    s_waitcnt vmcnt(8)
    ds_read_b128 v[110:113], v30 offset:12288
    ds_read_b128 v[114:117], v31 offset:12288
    ds_read_b128 v[118:121], v32 offset:12288
    ds_read_b128 v[122:125], v33 offset:12288
L_peek_1:
    s_waitcnt lgkmcnt(0)
    s_xor_b32 s56, s56, s6
    s_xor_b32 s57, s57, s6
    s_xor_b32 s58, s58, s6
    s_xor_b32 s59, s59, s6
    s_or_b64 s[56:57], s[56:57], s[58:59]
    s_cbranch_scc0 L_peeked_2
    s_add_u32 s60, s60, 64
    s_cmp_ge_u32 s60, 512
    s_cbranch_scc1 L_peeked_2
    s_add_u32 s8, s46, s60
    s_add_u32 s9, s47, s60
    s_load_dword s56, s[16:17], s8 offset:4
    s_load_dword s57, s[16:17], s8 offset:516
    s_load_dword s58, s[16:17], s9 offset:4
    s_load_dword s59, s[16:17], s9 offset:516
    s_branch L_peek_1
L_peeked_2:
    buffer_load_dwordx4 v[54:57], v28, s[16:19], s46 offen sc1
    buffer_load_dwordx4 v[58:61], v28, s[16:19], s47 offen sc1
    s_add_u32 m0, s42, 32768
    s_waitcnt vmcnt(9)
    buffer_load_dwordx4 v22, s[28:31], s39 offen offset:0 nt lds
    s_waitcnt vmcnt(9)
    buffer_load_dwordx4 v23, s[28:31], s39 offen offset:1024 nt lds
    s_waitcnt vmcnt(9)
    buffer_load_dwordx4 v22, s[28:31], s39 offen offset:2048 nt lds
    s_waitcnt vmcnt(9)
    buffer_load_dwordx4 v23, s[28:31], s39 offen offset:3072 nt lds
    s_add_u32 m0, s42, 49152
    s_waitcnt vmcnt(9)
    buffer_load_dwordx4 v22, s[28:31], s40 offen offset:0 nt lds
    s_waitcnt vmcnt(9)
    buffer_load_dwordx4 v23, s[28:31], s40 offen offset:1024 nt lds
    s_waitcnt vmcnt(9)
    buffer_load_dwordx4 v22, s[28:31], s40 offen offset:2048 nt lds
    s_waitcnt vmcnt(9)
    buffer_load_dwordx4 v23, s[28:31], s40 offen offset:3072 nt lds
    s_waitcnt vmcnt(8)
    s_mov_b32 s7, 0
    s_branch L_q_chk_4
L_q_retry_3:
    s_add_u32 s7, s7, 1
    s_cmp_gt_u32 s7, 1048576
    s_cbranch_scc1 L_q_done_5
    s_cmp_eq_u32 s7, 32
    s_cselect_b32 s10, -1, 0
    s_and_b32 s11, s10, 65536
    s_add_u32 s46, s46, s11
    s_add_u32 s47, s47, s11
    buffer_load_dwordx4 v[54:57], v28, s[16:19], s46 offen sc1
    buffer_load_dwordx4 v[58:61], v28, s[16:19], s47 offen sc1
    s_waitcnt vmcnt(0)
L_q_chk_4:
    v_xor_b32 v6, s6, v55
    v_bitop3_b32 v6, v6, v57, s6 bitop3:0xf6
    v_bitop3_b32 v6, v6, v59, s6 bitop3:0xf6
    v_bitop3_b32 v6, v6, v61, s6 bitop3:0xf6
    v_cmp_ne_u32 vcc, 0, v6
    s_cbranch_vccnz L_q_retry_3
L_q_done_5:
    v_add_f32 v54, v54, v58
    v_add_f32 v56, v56, v60
    v_cvt_pk_bf16_f32 v54, v54, v56
    ds_write_b32 v34, v54
    s_mov_b32 s69, 0x3fb8aa3b
    v_mov_b32 v232, 0
    v_mov_b32 v233, 0
    s_waitcnt vmcnt(10) lgkmcnt(0)
    s_barrier
    ds_read_b128 v[126:129], v35 offset:0
    ds_read_b128 v[130:133], v35 offset:64
    ds_read_b128 v[134:137], v35 offset:128
    ds_read_b128 v[138:141], v35 offset:192
    buffer_load_dword v16, v26, s[64:67], 0 offen
    buffer_load_dword v16, v15, s[20:23], 0 offen
    s_waitcnt lgkmcnt(3)
    v_mfma_f32_16x16x32_bf16 v[142:145], v[62:65], v[126:129], 0
    s_waitcnt lgkmcnt(2)
    v_mfma_f32_16x16x32_bf16 v[142:145], v[66:69], v[130:133], v[142:145]
    s_waitcnt lgkmcnt(1)
    v_mfma_f32_16x16x32_bf16 v[142:145], v[70:73], v[134:137], v[142:145]
    s_waitcnt lgkmcnt(0)
    v_mfma_f32_16x16x32_bf16 v[142:145], v[74:77], v[138:141], v[142:145]
    ds_read_b64_tr_b16 v[190:191], v36 offset:0
    ds_read_b64_tr_b16 v[192:193], v36 offset:4096
    v_mfma_f32_16x16x32_bf16 v[146:149], v[78:81], v[126:129], 0
    ds_read_b64_tr_b16 v[194:195], v37 offset:0
    ds_read_b64_tr_b16 v[196:197], v37 offset:4096
    v_mfma_f32_16x16x32_bf16 v[146:149], v[82:85], v[130:133], v[146:149]
    ds_read_b64_tr_b16 v[198:199], v36 offset:8192
    ds_read_b64_tr_b16 v[200:201], v36 offset:12288
    v_mfma_f32_16x16x32_bf16 v[146:149], v[86:89], v[134:137], v[146:149]
    ds_read_b64_tr_b16 v[202:203], v37 offset:8192
    ds_read_b64_tr_b16 v[204:205], v37 offset:12288
    v_mfma_f32_16x16x32_bf16 v[146:149], v[90:93], v[138:141], v[146:149]
    ds_read_b64_tr_b16 v[206:207], v36 offset:16384
    v_mfma_f32_16x16x32_bf16 v[150:153], v[94:97], v[126:129], 0
    ds_read_b64_tr_b16 v[208:209], v36 offset:20480
    v_mfma_f32_16x16x32_bf16 v[150:153], v[98:101], v[130:133], v[150:153]
    ds_read_b64_tr_b16 v[210:211], v37 offset:16384
    v_mfma_f32_16x16x32_bf16 v[150:153], v[102:105], v[134:137], v[150:153]
    ds_read_b64_tr_b16 v[212:213], v37 offset:20480
    v_mfma_f32_16x16x32_bf16 v[150:153], v[106:109], v[138:141], v[150:153]
    ds_read_b64_tr_b16 v[214:215], v36 offset:24576
    v_mfma_f32_16x16x32_bf16 v[154:157], v[110:113], v[126:129], 0
    ds_read_b64_tr_b16 v[216:217], v36 offset:28672
    v_mfma_f32_16x16x32_bf16 v[154:157], v[114:117], v[130:133], v[154:157]
    ds_read_b64_tr_b16 v[218:219], v37 offset:24576
    v_mfma_f32_16x16x32_bf16 v[154:157], v[118:121], v[134:137], v[154:157]
    ds_read_b64_tr_b16 v[220:221], v37 offset:28672
    v_mfma_f32_16x16x32_bf16 v[154:157], v[122:125], v[138:141], v[154:157]
    v_cndmask_b32 v222, v142, v146, s[50:51]
    v_cndmask_b32 v223, v143, v147, s[50:51]
    v_cndmask_b32 v224, v144, v148, s[50:51]
    v_cndmask_b32 v225, v145, v149, s[50:51]
    v_cndmask_b32 v222, v222, v150, s[52:53]
    v_cndmask_b32 v223, v223, v151, s[52:53]
    v_cndmask_b32 v224, v224, v152, s[52:53]
    v_cndmask_b32 v225, v225, v153, s[52:53]
    v_cndmask_b32 v222, v222, v154, s[54:55]
    v_cndmask_b32 v223, v223, v155, s[54:55]
    v_cndmask_b32 v224, v224, v156, s[54:55]
    v_cndmask_b32 v225, v225, v157, s[54:55]
    v_cvt_pk_bf16_f32 v222, 0, v222
    v_cvt_pk_bf16_f32 v223, 0, v223
    v_cvt_pk_bf16_f32 v224, 0, v224
    v_cvt_pk_bf16_f32 v225, 0, v225
    v_pk_mul_f32 v[222:223], v[222:223], v[52:53]
    v_pk_mul_f32 v[224:225], v[224:225], v[52:53]
    v_cvt_pk_bf16_f32 v222, 0, v222
    v_cvt_pk_bf16_f32 v223, 0, v223
    v_cvt_pk_bf16_f32 v224, 0, v224
    v_cvt_pk_bf16_f32 v225, 0, v225
    v_max3_f32 v226, v222, v223, v224
    v_max_f32 v226, v226, v225
    s_nop 1
    v_max_f32_dpp v226, v226, v226 row_ror:4 row_mask:0xf bank_mask:0xf
    s_nop 1
    v_max_f32_dpp v226, v226, v226 row_ror:8 row_mask:0xf bank_mask:0xf
    v_mov_b32 v6, v226
    s_nop 1
    v_permlane16_swap_b32 v226, v6
    v_max_f32 v226, v226, v6
    ds_write_b32 v40, v226
    s_waitcnt vmcnt(6) lgkmcnt(0)
    s_barrier
    ds_read_b128 v[6:9], v41
    ds_read_b128 v[10:13], v41 offset:16
    ds_read_b64_tr_b16 v[62:63], v36 offset:32768
    ds_read_b64_tr_b16 v[64:65], v36 offset:36864
    ds_read_b64_tr_b16 v[66:67], v37 offset:32768
    ds_read_b64_tr_b16 v[68:69], v37 offset:36864
    ds_read_b64_tr_b16 v[70:71], v36 offset:40960
    ds_read_b64_tr_b16 v[72:73], v36 offset:45056
    ds_read_b64_tr_b16 v[74:75], v37 offset:40960
    ds_read_b64_tr_b16 v[76:77], v37 offset:45056
    s_waitcnt lgkmcnt(9)
    v_max3_f32 v226, v6, v7, v8
    s_waitcnt lgkmcnt(8)
    v_max3_f32 v10, v10, v11, v12
    v_max3_f32 v226, v226, v9, v13
    v_max_f32 v226, v226, v10
    v_mul_f32 v226, s69, v226
    v_fma_f32 v222, v222, s69, -v226
    v_fma_f32 v223, v223, s69, -v226
    v_fma_f32 v224, v224, s69, -v226
    v_fma_f32 v225, v225, s69, -v226
    v_exp_f32 v222, v222
    v_exp_f32 v223, v223
    v_exp_f32 v224, v224
    v_exp_f32 v225, v225
    v_cvt_pk_bf16_f32 v230, v222, v223
    v_cvt_pk_bf16_f32 v231, v224, v225
    ds_write_b64 v38, v[230:231]
    v_mov_b32 v229, s6
    v_mfma_f32_16x16x32_bf16 v[150:153], v[44:47], v[230:233], 0
    s_nop 7
    ds_write_b32 v49, v150
    s_waitcnt vmcnt(2) lgkmcnt(0)
    s_barrier
    ds_read_b128 v[158:161], v39 offset:0
    ds_read_b128 v[126:129], v50 offset:0
    ds_read_b128 v[130:133], v50 offset:16
    ds_read_b128 v[134:137], v50 offset:32
    ds_read_b128 v[138:141], v50 offset:48
    ds_read_b128 v[162:165], v39 offset:256
    ds_read_b128 v[166:169], v39 offset:512
    ds_read_b128 v[170:173], v39 offset:768
    s_waitcnt lgkmcnt(7)
    v_mfma_f32_16x16x32_bf16 v[142:145], v[190:193], v[158:161], 0
    ds_read_b128 v[174:177], v39 offset:1024
    ds_read_b128 v[178:181], v39 offset:1280
    v_mfma_f32_16x16x32_bf16 v[146:149], v[194:197], v[158:161], 0
    s_waitcnt lgkmcnt(5)
    v_pk_add_f32 v[126:127], v[126:127], v[128:129]
    v_pk_add_f32 v[130:131], v[130:131], v[132:133]
    s_waitcnt lgkmcnt(4)
    v_mfma_f32_16x16x32_bf16 v[142:145], v[198:201], v[162:165], v[142:145]
    v_pk_add_f32 v[134:135], v[134:135], v[136:137]
    v_pk_add_f32 v[138:139], v[138:139], v[140:141]
    v_mfma_f32_16x16x32_bf16 v[146:149], v[202:205], v[162:165], v[146:149]
    v_pk_add_f32 v[126:127], v[126:127], v[130:131]
    v_pk_add_f32 v[134:135], v[134:135], v[138:139]
    s_waitcnt lgkmcnt(3)
    v_mfma_f32_16x16x32_bf16 v[142:145], v[206:209], v[166:169], v[142:145]
    v_pk_add_f32 v[126:127], v[126:127], v[134:135]
    v_add_f32 v126, v126, v127
    v_mfma_f32_16x16x32_bf16 v[146:149], v[210:213], v[166:169], v[146:149]
    v_log_f32 v228, v126
    v_rcp_f32 v222, v126
    s_waitcnt lgkmcnt(2)
    v_mfma_f32_16x16x32_bf16 v[142:145], v[214:217], v[170:173], v[142:145]
    v_add_f32 v228, v228, v226
    buffer_store_dwordx2 v[228:229], v48, s[16:19], s49 offen
    v_mfma_f32_16x16x32_bf16 v[146:149], v[218:221], v[170:173], v[146:149]
    ds_read_b128 v[182:185], v39 offset:1536
    ds_read_b128 v[186:189], v39 offset:1792
    s_waitcnt lgkmcnt(3)
    v_mfma_f32_16x16x32_bf16 v[142:145], v[62:65], v[174:177], v[142:145]
    ds_read_b64_tr_b16 v[78:79], v36 offset:49152
    ds_read_b64_tr_b16 v[80:81], v36 offset:53248
    v_mfma_f32_16x16x32_bf16 v[146:149], v[66:69], v[174:177], v[146:149]
    ds_read_b64_tr_b16 v[82:83], v37 offset:49152
    ds_read_b64_tr_b16 v[84:85], v37 offset:53248
    s_waitcnt lgkmcnt(6)
    v_mfma_f32_16x16x32_bf16 v[142:145], v[70:73], v[178:181], v[142:145]
    ds_read_b64_tr_b16 v[86:87], v36 offset:57344
    ds_read_b64_tr_b16 v[88:89], v36 offset:61440
    v_mfma_f32_16x16x32_bf16 v[146:149], v[74:77], v[178:181], v[146:149]
    ds_read_b64_tr_b16 v[90:91], v37 offset:57344
    ds_read_b64_tr_b16 v[92:93], v37 offset:61440
    s_waitcnt lgkmcnt(4)
    v_mfma_f32_16x16x32_bf16 v[142:145], v[78:81], v[182:185], v[142:145]
    v_mfma_f32_16x16x32_bf16 v[146:149], v[82:85], v[182:185], v[146:149]
    s_waitcnt lgkmcnt(0)
    v_mfma_f32_16x16x32_bf16 v[142:145], v[86:89], v[186:189], v[142:145]
    v_mfma_f32_16x16x32_bf16 v[146:149], v[90:93], v[186:189], v[146:149]
    s_mov_b32 exec_lo, 0xf000f
    s_mov_b32 exec_hi, 0xf000f
    s_nop 4
    v_pk_mul_f32 v[142:143], v[142:143], v[222:223] op_sel_hi:[1,0]
    v_pk_mul_f32 v[144:145], v[144:145], v[222:223] op_sel_hi:[1,0]
    v_pk_mul_f32 v[146:147], v[146:147], v[222:223] op_sel_hi:[1,0]
    v_pk_mul_f32 v[148:149], v[148:149], v[222:223] op_sel_hi:[1,0]
    v_cvt_pk_bf16_f32 v6, v142, v143
    v_cvt_pk_bf16_f32 v7, v144, v145
    v_cvt_pk_bf16_f32 v8, v146, v147
    v_cvt_pk_bf16_f32 v9, v148, v149
    buffer_store_dwordx4 v[6:9], v42, s[16:19], s48 offen
    s_add_u32 s48, s48, 8192
    s_add_u32 s49, s49, 0x4000
    buffer_store_dwordx4 v[6:9], v42, s[16:19], s48 offen sc1
    s_mov_b64 exec, -1
    buffer_store_dwordx2 v[228:229], v48, s[16:19], s49 offen sc1
    buffer_load_dword v25, v25, s[32:35], 0 offen
    s_endpgm
L_end:
    s_endpgm
L_codeend:
.section .rodata,"a"
.p2align 6
.amdhsa_kernel adaLN_cond__sliding_block_cached__swiglu_ffn__decode_kernel
  .amdhsa_next_free_vgpr 236
  .amdhsa_next_free_sgpr 70
  .amdhsa_accum_offset 236
  .amdhsa_group_segment_fixed_size 0
  .amdhsa_kernarg_size 112
  .amdhsa_user_sgpr_count 2
  .amdhsa_user_sgpr_kernarg_segment_ptr 1
  .amdhsa_system_sgpr_workgroup_id_x 1
  .amdhsa_float_denorm_mode_32 3
.end_amdhsa_kernel
```
